```python
import torch

def _softmax(x, axis=-1):
    return torch.softmax(x, dim=axis)
def _gelu(x):
    return torch.nn.functional.gelu(x, approximate="tanh")
def _silu(x):
    return torch.nn.functional.silu(x)
def _sigmoid(x):
    return torch.sigmoid(x)
def _layernorm(x, axis=-1, eps=1e-5):
    m = x.mean(dim=axis, keepdim=True)
    v = x.var(dim=axis, keepdim=True, unbiased=False)
    return (x - m) / torch.sqrt(v + eps)
def _scatter_add(tgt, idx, src, axis=0):
    return tgt.clone().index_add_(axis, idx, src)
def _segment_sum(src, seg, n):
    out = torch.zeros((n,) + src.shape[1:], dtype=src.dtype)
    return out.index_add_(0, seg, src)
def _pad(x, pw):
    flat = tuple(v for pair in reversed(pw) for v in pair)
    return torch.nn.functional.pad(x, flat)

kernel_name = 'sequential_preLN__spectral_fnet__dense_activation_relu__prompt'

def setup_inputs():

    _w = (lambda a: (lambda t: t.to(torch.bfloat16) if t.is_floating_point() else t)(torch.as_tensor(a)))
    def _A_setup():
        B, S, D = 1, 2048, 640
        ns = torch.arange(S)[:, None] * torch.arange(S)[None, :]
        nd = torch.arange(D)[:, None] * torch.arange(D)[None, :]
        Ws_re = torch.cos(-2.0 * torch.pi * ns / S).to(float)
        Ws_im = torch.sin(-2.0 * torch.pi * ns / S).to(float)
        Wd_re = torch.cos(-2.0 * torch.pi * nd / D).to(float)
        Wd_im = torch.sin(-2.0 * torch.pi * nd / D).to(float)
        return {
            "x": _w((lambda *s: torch.randn(*s, dtype=torch.bfloat16) * 0.05)(B, S, D)),
            "dft_seq_re": _w(Ws_re),
            "dft_seq_im": _w(Ws_im),
            "dft_hid_re": _w(Wd_re),
            "dft_hid_im": _w(Wd_im),
        }
    _A_in = _A_setup()

    def _B_setup():
        B, S, D, Dff = 1, 2048, 640, 1728
        return {
            "x": _w((lambda *s: torch.randn(*s, dtype=torch.bfloat16) * 0.05)(B, S, D)),
            "w1": _w((lambda *s: torch.randn(*s, dtype=torch.bfloat16) * 0.4)(D, Dff)),
            "w2": _w((lambda *s: torch.randn(*s, dtype=torch.bfloat16) * 0.4)(Dff, D)),
        }
    _B_in = _B_setup()

    return {
        "A_x": _A_in["x"],
        "A_dft_seq_re": _A_in["dft_seq_re"],
        "A_dft_seq_im": _A_in["dft_seq_im"],
        "A_dft_hid_re": _A_in["dft_hid_re"],
        "A_dft_hid_im": _A_in["dft_hid_im"],
        "B_x": _B_in["x"],
        "B_w1": _B_in["w1"],
        "B_w2": _B_in["w2"],
    }

def reference(A_x, A_dft_seq_re, A_dft_seq_im, A_dft_hid_re, A_dft_hid_im, B_x, B_w1, B_w2):
    def _A_ref(x, dft_seq_re, dft_seq_im, dft_hid_re, dft_hid_im):
        a = torch.einsum("bsd,ed->bse", x, dft_hid_re)
        b = torch.einsum("bsd,ed->bse", x, dft_hid_im)
        y = torch.einsum("ts,bse->bte", dft_seq_re, a) - torch.einsum("ts,bse->bte", dft_seq_im, b)
        return y

    def _B_ref(x, w1, w2):
        h = torch.einsum("bsd,df->bsf", x, w1)
        zero = torch.zeros_like(h)
        h = torch.maximum(h, zero)
        return torch.einsum("bsf,fd->bsd", h, w2)

    x = A_x
    h = x + _A_ref(_layernorm(x, axis=-1), A_dft_seq_re, A_dft_seq_im, A_dft_hid_re, A_dft_hid_im)
    h2 = h + _B_ref(_layernorm(h, axis=-1), B_w1, B_w2)
    return h2
```

```asm
; @launch grid=(256,1,1) block=(256,1,1) lds=163840
.amdgcn_target "amdgcn-amd-amdhsa--gfx950"
.text
.globl sequential_preLN__spectral_fnet__dense_activation_relu__prompt_kernel
.p2align 8
.type sequential_preLN__spectral_fnet__dense_activation_relu__prompt_kernel,@function
sequential_preLN__spectral_fnet__dense_activation_relu__prompt_kernel:
    s_load_dwordx2 s[4:5], s[0:1], 0
    s_load_dwordx2 s[8:9], s[0:1], 80
    s_load_dwordx4 s[24:27], s[0:1], 48
    s_load_dwordx4 s[28:31], s[0:1], 64
    s_cmp_ge_u32 s2, 256
    s_cbranch_scc1 L_done
    s_getpc_b64 s[46:47]
Lpc1:
    s_bfe_u32 s3, s2, 0x30003
    v_lshl_add_u32 v6, v0, 3, s3
    v_lshlrev_b32 v6, 7, v6
    v_cmp_gt_u32 vcc, L_done - Lpc1, v6
    s_and_saveexec_b64 s[44:45], vcc
    s_cbranch_execz Lnopf2
    global_load_dword a255, v6, s[46:47]
Lnopf2:
    s_mov_b64 exec, -1
    v_lshrrev_b32 v8, 6, v0
    v_and_b32 v1, 63, v0
    v_readfirstlane_b32 s20, v8
    v_lshrrev_b32 v238, 3, v1
    v_and_b32 v7, 7, v1
    v_mul_u32_u24 v10, 81920, v238
    v_lshlrev_b32 v8, 1, v238
    v_and_b32 v8, 4, v8
    v_xor_b32 v8, v8, v7
    v_lshl_add_u32 v10, v8, 4, v10
    s_mov_b32 s6, 2621440
    s_mov_b32 s7, 0x20000
    s_and_b32 s21, s2, 63
    s_lshr_b32 s22, s2, 6
    s_xor_b32 s22, s22, 3
    s_mul_i32 s23, s21, 1280
    s_mul_i32 s3, s20, 655360
    s_add_u32 s23, s23, s3
    s_lshl_b32 s52, s20, 10
    s_add_u32 s53, s52, 53248
    s_add_u32 s54, s23, 640
    s_add_u32 s55, s53, 20480
    s_bitcmp1_b32 s22, 0
    s_cselect_b32 s62, s54, s23
    s_cselect_b32 s63, s55, s53
    s_cselect_b32 s23, s23, s54
    s_cselect_b32 s53, s53, s55
    s_mov_b32 s10, 25165824
    s_mov_b32 s11, 0x20000
    v_mov_b32 v233, 0
    s_lshl_b32 s50, s20, 3
    s_or_b32 s50, s50, s2
    v_and_b32 v6, 1, v1
    v_lshrrev_b32 v2, 4, v1
    v_and_b32 v3, 15, v1
    v_lshlrev_b32 v4, 4, v1
    v_mov_b32 v5, 1
    s_cmp_ge_u32 s50, 8
    s_waitcnt lgkmcnt(0)
    s_cbranch_scc1 LA_nozero
    v_lshlrev_b32 v243, 8, v1
    s_lshl_b32 s3, s2, 14
    buffer_store_dword v233, v243, s[8:11], s3 offen sc1
LA_nozero:
    s_add_u32 m0, s63, 0
    s_nop 0
    buffer_load_dwordx4 v10, s[4:7], s62 offen offset:0  lds
    s_add_u32 m0, s63, 3968
    s_nop 0
    buffer_load_dwordx4 v10, s[4:7], s62 offen offset:128  lds
    s_add_u32 m0, s63, 7936
    s_nop 0
    buffer_load_dwordx4 v10, s[4:7], s62 offen offset:256  lds
    s_add_u32 m0, s63, 11904
    s_nop 0
    buffer_load_dwordx4 v10, s[4:7], s62 offen offset:384  lds
    s_add_u32 m0, s63, 15872
    s_nop 0
    buffer_load_dwordx4 v10, s[4:7], s62 offen offset:512  lds
    v_lshrrev_b32 v241, 3, v3
    s_add_u32 s41, s22, 1
    s_cmp_lt_u32 s22, 3
    s_cselect_b32 s41, s41, 0
    s_cselect_b32 s42, 0, 4
    s_cselect_b32 s43, 2, 0
    v_mul_u32_u24 v7, s42, v241
    v_add_u32 v7, s41, v7
    v_mul_u32_u24 v8, s43, v241
    v_mad_u32_u24 v8, v7, v2, v8
    v_cvt_f32_u32 v8, v8
    v_mul_f32 v8, 0x3e000000, v8
    v_cos_f32 v8, v8
    v_and_b32 v7, 1, v7
    s_add_u32 m0, s53, 0
    s_nop 0
    buffer_load_dwordx4 v10, s[4:7], s23 offen offset:0  lds
    v_lshlrev_b32 v7, 15, v7
    v_cvt_pk_bf16_f32 v244, v8, 0
    v_mov_b32 v245, 0
    v_xor_b32 v246, v7, v244
    v_mov_b32 v247, 0
    v_and_b32 v7, 3, v1
    v_lshlrev_b32 v8, 4, v7
    v_bfe_u32 v242, v3, 2, 1
    v_lshlrev_b64 v[244:245], v8, v[244:245]
    v_lshlrev_b64 v[246:247], v8, v[246:247]
    v_cmp_eq_u32 vcc, 0, v242
    v_lshlrev_b32 v13, 31, v6
    v_lshrrev_b32 v8, 16, v13
    v_cndmask_b32 v56, 0, v244, vcc
    s_add_u32 m0, s53, 3968
    s_nop 0
    buffer_load_dwordx4 v10, s[4:7], s23 offen offset:128  lds
    v_cndmask_b32 v58, v244, v233, vcc
    v_cndmask_b32 v57, 0, v245, vcc
    v_cndmask_b32 v59, v245, v233, vcc
    v_cndmask_b32 v60, 0, v246, vcc
    v_cndmask_b32 v62, v246, v233, vcc
    v_cndmask_b32 v61, 0, v247, vcc
    v_cndmask_b32 v63, v247, v233, vcc
    v_or_b32 v13, v13, v8
    v_bfe_u32 v7, v3, 1, 1
    v_lshrrev_b32 v8, 2, v3
    v_lshl_add_u32 v8, s20, 2, v8
    v_mul_u32_u24 v229, 204800, v8
    v_lshl_add_u32 v229, v7, 6, v229
    v_lshl_add_u32 v229, v6, 5, v229
    s_add_u32 m0, s53, 7936
    s_nop 0
    buffer_load_dwordx4 v10, s[4:7], s23 offen offset:256  lds
    v_sub_u32 v9, 32, v8
    v_cmp_eq_u32 vcc, 0, v8
    v_and_b32 v244, 1, v2
    v_lshrrev_b32 v245, 1, v2
    v_cndmask_b32 v9, v9, 16, vcc
    v_cmp_eq_u32 vcc, 0, v7
    v_lshl_add_u32 v228, v244, 4, v229
    v_xor_b32 v7, v7, v245
    v_cndmask_b32 v8, v9, v8, vcc
    v_lshl_add_u32 v226, v7, 15, v228
    v_lshl_add_u32 v227, v7, 14, v228
    v_lshl_add_u32 v228, v245, 13, v228
    v_lshl_add_u32 v229, v2, 3, v229
    v_lshlrev_b32 v11, 3, v244
    s_add_u32 m0, s53, 11904
    s_nop 0
    buffer_load_dwordx4 v10, s[4:7], s23 offen offset:384  lds
    s_movk_i32 s54, 5120
    v_mad_u32_u24 v11, v245, s54, v11
    v_lshlrev_b32 v224, 31, v8
    v_cvt_f32_u32 v8, v8
    v_mul_f32 v8, 0x3d000000, v8
    v_cvt_f32_u32 v7, v6
    v_fmaak_f32 v7, 0x3e800000, v7, 0x3e800000
    v_lshlrev_b32 v9, 2, v2
    v_cvt_f32_u32 v112, v9
    v_fma_f32 v244, v8, v112, v7
    v_add_f32 v245, v244, v8
    v_add_f32 v246, v245, v8
    v_add_f32 v247, v246, v8
    v_lshrrev_b32 v7, 16, v224
    s_add_u32 m0, s53, 15872
    s_nop 0
    buffer_load_dwordx4 v10, s[4:7], s23 offen offset:512  lds
    v_or_b32 v224, v224, v7
    v_sin_f32 v248, v244
    v_cos_f32 v252, v244
    v_sin_f32 v249, v245
    v_cos_f32 v253, v245
    v_sin_f32 v250, v246
    v_cos_f32 v254, v246
    v_sin_f32 v251, v247
    v_cos_f32 v255, v247
    v_cvt_pk_bf16_f32 v64, v248, v249
    v_cvt_pk_bf16_f32 v68, -v252, -v253
    v_cvt_pk_bf16_f32 v65, v250, v251
    v_cvt_pk_bf16_f32 v69, -v254, -v255
    v_xor_b32 v66, v224, v64
    v_xor_b32 v70, v224, v68
    v_xor_b32 v67, v224, v65
    v_xor_b32 v71, v224, v69
    v_lshl_add_u32 v6, s20, 4, v9
    v_cvt_f32_u32 v234, v6
    v_add_f32 v235, 1.0, v234
    v_add_f32 v236, 2.0, v234
    v_add_f32 v237, 1.0, v236
    v_add_u32 v239, s52, v4
    v_and_b32 v6, 7, v1
    v_lshl_add_u32 v7, s20, 3, v6
    s_movk_i32 s54, 160
    v_mad_u32_u24 v11, v7, s54, v11
    v_lshl_add_u32 v11, v241, 4, v11
    v_lshrrev_b32 v7, 2, v1
    v_mul_u32_u24 v12, 160, v7
    v_and_b32 v8, 3, v1
    v_lshl_add_u32 v12, v8, 3, v12
    v_lshl_add_u32 v7, v6, 7, s52
    v_lshlrev_b32 v6, 5, v6
    v_and_b32 v6, 0x40, v6
    v_mad_u32_u24 v8, v2, 10, v241
    s_movk_i32 s54, 1664
    v_lshl_add_u32 v8, v8, 4, s54
    s_movk_i32 s54, 0x70
    s_movk_i32 s55, 0xfff
    v_xor_b32 v9, v6, v8
    v_lshlrev_b32 v244, 5, v8
    v_and_or_b32 v9, v9, s54, v7
    v_bfi_b32 v172, s55, v9, v244
    v_add_u32 v8, 32, v8
    v_xor_b32 v9, v6, v8
    v_lshlrev_b32 v244, 5, v8
    v_and_or_b32 v9, v9, s54, v7
    v_bfi_b32 v173, s55, v9, v244
    v_add_u32 v8, 32, v8
    v_xor_b32 v9, v6, v8
    v_lshlrev_b32 v244, 5, v8
    v_and_or_b32 v9, v9, s54, v7
    v_bfi_b32 v174, s55, v9, v244
    v_add_u32 v8, 32, v8
    v_xor_b32 v9, v6, v8
    v_lshlrev_b32 v244, 5, v8
    v_and_or_b32 v9, v9, s54, v7
    v_bfi_b32 v175, s55, v9, v244
    v_add_u32 v8, 32, v8
    v_xor_b32 v9, v6, v8
    v_lshlrev_b32 v244, 5, v8
    v_and_or_b32 v9, v9, s54, v7
    v_bfi_b32 v176, s55, v9, v244
    s_mov_b32 s12, s26
    s_mov_b32 s13, s27
    s_mov_b32 s14, 2211840
    s_mov_b32 s15, 0x20000
    s_mov_b32 s26, 2211840
    s_mov_b32 s27, 0x20000
    s_mov_b32 s16, s28
    s_mov_b32 s17, s29
    s_mov_b32 s18, 2621440
    s_mov_b32 s19, 0x20000
    s_mov_b32 s56, s30
    s_mov_b32 s57, s31
    s_mov_b32 s58, 256
    s_mov_b32 s59, 0x20000
    s_mov_b32 s51, 0x3f803f80
    s_getpc_b64 s[46:47]
    s_add_u32 s46, s46, w1_lane_table@rel32@lo+4
    s_addc_u32 s47, s47, w1_lane_table@rel32@hi+12
    s_lshr_b32 s3, s22, 1
    s_and_b32 s3, s3, s2
    s_lshl_b32 s3, s3, 11
    v_lshl_add_u32 v8, v4, 1, s3
    global_load_dwordx4 a[240:243], v8, s[46:47]
    global_load_dwordx4 a[244:247], v8, s[46:47] offset:16
    s_cmp_eq_u32 s20, 1
    s_cbranch_scc0 Lopt3
    v_mul_u32_u24 v8, 2097152, v1
    s_lshl_b32 s3, s2, 7
    buffer_load_dword a252, v8, s[8:11], s3 offen
    buffer_load_dword a251, v8, s[16:19], s3 offen
    buffer_load_dword a250, v8, s[12:15], s3 offen
    buffer_load_dword a249, v8, s[24:27], s3 offen
Lopt3:
    s_cmp_eq_u32 s22, 3
    s_cbranch_scc1 LA_second
    v_cvt_f32_u32 v112, v2
    v_fmaak_f32 v112, 4.0, v112, 0x42800000
    v_add_f32 v113, 1.0, v112
    v_add_f32 v114, 2.0, v112
    v_add_f32 v115, 1.0, v114
    v_and_b32 v7, 3, v3
    v_mad_u32_u24 v7, v242, 8, v7
    v_mad_u32_u24 v7, v241, 64, v7
    v_lshl_add_u32 v7, v7, 3, s41
    v_cvt_f32_u32 v7, v7
    v_mul_f32 v7, 0x3acccccd, v7
    v_add_f32 v6, 0x0, v7
    v_pk_mul_f32 v[244:245], v[234:235], v[6:7] op_sel_hi:[1,0]
    v_pk_mul_f32 v[246:247], v[236:237], v[6:7] op_sel_hi:[1,0]
    v_cos_f32 v248, v244
    v_sin_f32 v252, v244
    v_cos_f32 v249, v245
    v_sin_f32 v253, v245
    v_cos_f32 v250, v246
    v_sin_f32 v254, v246
    v_cos_f32 v251, v247
    v_sin_f32 v255, v247
    v_cvt_pk_bf16_f32 v92, v248, v249
    v_cvt_pk_bf16_f32 v93, v250, v251
    v_cvt_pk_bf16_f32 v94, v252, v253
    v_cvt_pk_bf16_f32 v95, v254, v255
    ds_write_b128 v239, v[92:95] offset:0
    v_add_f32 v6, 0x3d4ccccd, v7
    v_pk_mul_f32 v[244:245], v[234:235], v[6:7] op_sel_hi:[1,0]
    v_pk_mul_f32 v[246:247], v[236:237], v[6:7] op_sel_hi:[1,0]
    v_cos_f32 v248, v244
    v_sin_f32 v252, v244
    v_cos_f32 v249, v245
    v_sin_f32 v253, v245
    v_cos_f32 v250, v246
    v_sin_f32 v254, v246
    v_cos_f32 v251, v247
    v_sin_f32 v255, v247
    v_cvt_pk_bf16_f32 v96, v248, v249
    v_cvt_pk_bf16_f32 v97, v250, v251
    v_cvt_pk_bf16_f32 v98, v252, v253
    v_cvt_pk_bf16_f32 v99, v254, v255
    ds_write_b128 v239, v[96:99] offset:5120
    s_lshl_b32 s3, s20, 3
    s_lshr_b32 s42, 538984512, s3
    s_and_b32 s42, s42, 255
    s_lshr_b32 s43, 134744072, s3
    s_and_b32 s43, s43, 255
    s_lshr_b32 s44, 673187840, s3
    s_and_b32 s44, s44, 255
    s_lshl_b32 s44, s44, 2
    s_add_u32 s44, s44, s41
    s_mul_i32 s45, s20, 5120
    v_and_b32 v6, 3, v3
    v_mad_u32_u24 v6, v242, s43, v6
    v_mad_u32_u24 v6, v241, s42, v6
    v_lshl_add_u32 v6, v6, 3, s44
    v_cvt_f32_u32 v6, v6
    v_mul_f32 v6, 0x3acccccd, v6
    v_add_u32 v240, s45, v4
    v_pk_mul_f32 v[244:245], v[112:113], v[6:7] op_sel_hi:[1,0]
    v_pk_mul_f32 v[246:247], v[114:115], v[6:7] op_sel_hi:[1,0]
    v_cos_f32 v248, v244
    v_sin_f32 v252, v244
    v_cos_f32 v249, v245
    v_sin_f32 v253, v245
    v_cos_f32 v250, v246
    v_sin_f32 v254, v246
    v_cos_f32 v251, v247
    v_sin_f32 v255, v247
    v_cvt_pk_bf16_f32 v100, v248, v249
    v_cvt_pk_bf16_f32 v101, v250, v251
    v_cvt_pk_bf16_f32 v102, v252, v253
    v_cvt_pk_bf16_f32 v103, v254, v255
    ds_write_b128 v240, v[100:103] offset:4096
    v_and_b32 v7, 3, v3
    v_mad_u32_u24 v7, v242, 8, v7
    v_mad_u32_u24 v7, v241, 32, v7
    v_lshl_add_u32 v7, v7, 3, s41
    v_cvt_f32_u32 v7, v7
    v_mul_f32 v7, 0x3acccccd, v7
    v_add_f32 v6, 0x3e4ccccd, v7
    v_pk_mul_f32 v[244:245], v[234:235], v[6:7] op_sel_hi:[1,0]
    v_pk_mul_f32 v[246:247], v[236:237], v[6:7] op_sel_hi:[1,0]
    v_cos_f32 v248, v244
    v_sin_f32 v252, v244
    v_cos_f32 v249, v245
    v_sin_f32 v253, v245
    v_cos_f32 v250, v246
    v_sin_f32 v254, v246
    v_cos_f32 v251, v247
    v_sin_f32 v255, v247
    v_cvt_pk_bf16_f32 v92, v248, v249
    v_cvt_pk_bf16_f32 v93, v250, v251
    v_cvt_pk_bf16_f32 v94, v252, v253
    v_cvt_pk_bf16_f32 v95, v254, v255
    ds_write_b128 v239, v[92:95] offset:10240
    v_add_f32 v6, 0x3e800000, v7
    v_pk_mul_f32 v[244:245], v[234:235], v[6:7] op_sel_hi:[1,0]
    v_pk_mul_f32 v[246:247], v[236:237], v[6:7] op_sel_hi:[1,0]
    v_cos_f32 v248, v244
    v_sin_f32 v252, v244
    v_cos_f32 v249, v245
    v_sin_f32 v253, v245
    v_cos_f32 v250, v246
    v_sin_f32 v254, v246
    v_cos_f32 v251, v247
    v_sin_f32 v255, v247
    v_cvt_pk_bf16_f32 v96, v248, v249
    v_cvt_pk_bf16_f32 v97, v250, v251
    v_cvt_pk_bf16_f32 v98, v252, v253
    v_cvt_pk_bf16_f32 v99, v254, v255
    ds_write_b128 v239, v[96:99] offset:15360
    s_cmp_lg_u32 s20, 0
    s_cbranch_scc1 Lls4
    s_lshl_b32 s3, s20, 3
    s_lshr_b32 s42, 134744072, s3
    s_and_b32 s42, s42, 255
    s_lshr_b32 s43, 67372036, s3
    s_and_b32 s43, s43, 255
    s_lshr_b32 s44, 1077952576, s3
    s_and_b32 s44, s44, 255
    s_lshl_b32 s44, s44, 2
    s_add_u32 s44, s44, s41
    s_mul_i32 s45, s20, 5120
    v_and_b32 v6, 3, v3
    v_mad_u32_u24 v6, v242, s43, v6
    v_mad_u32_u24 v6, v241, s42, v6
    v_lshl_add_u32 v6, v6, 3, s44
    v_cvt_f32_u32 v6, v6
    v_mul_f32 v6, 0x3acccccd, v6
    v_add_u32 v240, s45, v4
    v_pk_mul_f32 v[244:245], v[112:113], v[6:7] op_sel_hi:[1,0]
    v_pk_mul_f32 v[246:247], v[114:115], v[6:7] op_sel_hi:[1,0]
    v_cos_f32 v248, v244
    v_sin_f32 v252, v244
    v_cos_f32 v249, v245
    v_sin_f32 v253, v245
    v_cos_f32 v250, v246
    v_sin_f32 v254, v246
    v_cos_f32 v251, v247
    v_sin_f32 v255, v247
    v_cvt_pk_bf16_f32 v100, v248, v249
    v_cvt_pk_bf16_f32 v101, v250, v251
    v_cvt_pk_bf16_f32 v102, v252, v253
    v_cvt_pk_bf16_f32 v103, v254, v255
    ds_write_b128 v240, v[100:103] offset:24576
Lls4:
    v_and_b32 v7, 3, v3
    v_mad_u32_u24 v7, v242, 4, v7
    v_mad_u32_u24 v7, v241, 8, v7
    v_lshl_add_u32 v7, v7, 3, s41
    v_cvt_f32_u32 v7, v7
    v_mul_f32 v7, 0x3acccccd, v7
    v_add_f32 v6, 0x3ecccccd, v7
    v_pk_mul_f32 v[244:245], v[234:235], v[6:7] op_sel_hi:[1,0]
    v_pk_mul_f32 v[246:247], v[236:237], v[6:7] op_sel_hi:[1,0]
    v_cos_f32 v248, v244
    v_sin_f32 v252, v244
    v_cos_f32 v249, v245
    v_sin_f32 v253, v245
    v_cos_f32 v250, v246
    v_sin_f32 v254, v246
    v_cos_f32 v251, v247
    v_sin_f32 v255, v247
    v_cvt_pk_bf16_f32 v92, v248, v249
    v_cvt_pk_bf16_f32 v93, v250, v251
    v_cvt_pk_bf16_f32 v94, v252, v253
    v_cvt_pk_bf16_f32 v95, v254, v255
    ds_write_b128 v239, v[92:95] offset:20480
    v_sub_u32 v6, v3, v2
    v_mad_i32_i24 v6, v2, -3, v6
    v_cmp_eq_u32 s[0:1], 0, v6
    v_cmp_eq_u32 s[62:63], 1, v6
    v_cmp_eq_u32 s[100:101], 2, v6
    v_cmp_eq_u32 s[28:29], 3, v6
    s_mov_b32 s48, 0x3acccccd
    v_mov_b32 v100, s51
    v_mov_b32 v101, s51
    v_mov_b32 v102, s51
    v_mov_b32 v103, s51
    s_waitcnt lgkmcnt(0)
    s_barrier
    s_waitcnt vmcnt(0)
    ds_read_b128 v[16:19], v172 offset:0
    ds_read_b128 v[20:23], v172 offset:20480
    ds_read_b128 v[24:27], v173 offset:0
    ds_read_b128 v[28:31], v173 offset:20480
    ds_read_b128 v[32:35], v174 offset:0
    ds_read_b128 v[36:39], v174 offset:20480
    ds_read_b128 v[40:43], v175 offset:0
    ds_read_b128 v[44:47], v175 offset:20480
    ds_read_b128 v[48:51], v176 offset:0
    ds_read_b128 v[52:55], v176 offset:20480
    s_lshl_b32 s3, s2, 2
    s_add_u32 s3, s3, s20
    s_mul_i32 s3, s3, 2176
    v_lshlrev_b32 v8, 7, v1
    s_bfm_b64 exec, 17, 0
    buffer_load_dword a254, v8, s[24:27], s3 offen
    buffer_load_dword a253, v8, s[12:15], s3 offen
    s_lshl_b32 s3, s2, 2
    s_add_u32 s3, s3, s20
    s_mul_i32 s3, s3, 2560
    s_mov_b64 exec, 0xc0300
    buffer_load_dword a248, v8, s[16:19], s3 offen
    s_mov_b64 exec, -1
    s_waitcnt lgkmcnt(9)
    v_mfma_f32_16x16x32_bf16 v[92:95], v[16:19], v[16:19], 0
    ds_read_b128 a[0:3], v4 offset:0
    v_mfma_f32_16x16x32_bf16 v[96:99], v[100:103], v[16:19], 0
    s_waitcnt lgkmcnt(9)
    v_mfma_f32_16x16x32_bf16 v[92:95], v[20:23], v[20:23], v[92:95]
    ds_read_b128 a[4:7], v4 offset:1024
    v_mfma_f32_16x16x32_bf16 v[96:99], v[100:103], v[20:23], v[96:99]
    s_waitcnt lgkmcnt(9)
    v_mfma_f32_16x16x32_bf16 v[92:95], v[24:27], v[24:27], v[92:95]
    ds_read_b128 a[8:11], v4 offset:2048
    v_mfma_f32_16x16x32_bf16 v[96:99], v[100:103], v[24:27], v[96:99]
    s_waitcnt lgkmcnt(9)
    v_mfma_f32_16x16x32_bf16 v[92:95], v[28:31], v[28:31], v[92:95]
    ds_read_b128 a[12:15], v4 offset:3072
    v_mfma_f32_16x16x32_bf16 v[96:99], v[100:103], v[28:31], v[96:99]
    ds_read_b128 a[16:19], v4 offset:4096
    s_waitcnt lgkmcnt(10)
    v_mfma_f32_16x16x32_bf16 v[92:95], v[32:35], v[32:35], v[92:95]
    ds_read_b128 a[20:23], v4 offset:5120
    v_mfma_f32_16x16x32_bf16 v[96:99], v[100:103], v[32:35], v[96:99]
    ds_read_b128 a[24:27], v4 offset:6144
    s_waitcnt lgkmcnt(11)
    v_mfma_f32_16x16x32_bf16 v[92:95], v[36:39], v[36:39], v[92:95]
    ds_read_b128 a[28:31], v4 offset:7168
    v_mfma_f32_16x16x32_bf16 v[96:99], v[100:103], v[36:39], v[96:99]
    ds_read_b128 a[32:35], v4 offset:8192
    s_waitcnt lgkmcnt(12)
    v_mfma_f32_16x16x32_bf16 v[92:95], v[40:43], v[40:43], v[92:95]
    ds_read_b128 a[36:39], v4 offset:9216
    v_mfma_f32_16x16x32_bf16 v[96:99], v[100:103], v[40:43], v[96:99]
    ds_read_b128 a[40:43], v4 offset:10240
    s_waitcnt lgkmcnt(13)
    v_mfma_f32_16x16x32_bf16 v[92:95], v[44:47], v[44:47], v[92:95]
    ds_read_b128 a[44:47], v4 offset:11264
    v_mfma_f32_16x16x32_bf16 v[96:99], v[100:103], v[44:47], v[96:99]
    ds_read_b128 a[48:51], v4 offset:12288
    s_waitcnt lgkmcnt(14)
    v_mfma_f32_16x16x32_bf16 v[92:95], v[48:51], v[48:51], v[92:95]
    ds_read_b128 a[52:55], v4 offset:13312
    v_mfma_f32_16x16x32_bf16 v[96:99], v[100:103], v[48:51], v[96:99]
    ds_read_b128 a[56:59], v4 offset:14336
    s_waitcnt lgkmcnt(15)
    v_mfma_f32_16x16x32_bf16 v[92:95], v[52:55], v[52:55], v[92:95]
    ds_read_b128 a[60:63], v4 offset:15360
    v_mfma_f32_16x16x32_bf16 v[96:99], v[100:103], v[52:55], v[96:99]
    ds_read_b128 a[64:67], v4 offset:16384
    v_mfma_f32_16x16x32_bf16 v[72:75], v[56:59], v[16:19], 0
    v_mfma_f32_16x16x32_bf16 v[76:79], v[56:59], v[24:27], 0
    v_mfma_f32_16x16x32_bf16 v[80:83], v[56:59], v[32:35], 0
    ds_read_b128 a[68:71], v4 offset:17408
    ds_read_b128 a[72:75], v4 offset:18432
    ds_read_b128 a[76:79], v4 offset:19456
    ds_read_b128 a[80:83], v4 offset:20480
    ds_read_b128 a[84:87], v4 offset:21504
    ds_read_b128 a[88:91], v4 offset:22528
    ds_read_b128 a[92:95], v4 offset:23552
    ds_read_b128 a[96:99], v4 offset:24576
    v_cndmask_b32 v15, 0, v92, s[0:1]
    v_cndmask_b32 v15, v15, v93, s[62:63]
    v_mfma_f32_16x16x32_bf16 v[84:87], v[56:59], v[40:43], 0
    v_cndmask_b32 v15, v15, v94, s[100:101]
    v_cndmask_b32 v15, v15, v95, s[28:29]
    v_mfma_f32_16x16x32_bf16 v[88:91], v[56:59], v[48:51], 0
    v_add_f32_dpp v14, v96, v96 row_ror:8 row_mask:0xf bank_mask:0xf
    v_mov_b32 v224, v15
    v_mfma_f32_16x16x32_bf16 v[72:75], v[60:63], v[20:23], v[72:75]
    v_mul_f32 v14, 0x3acccccd, v14
    v_permlane32_swap_b32 v224, v15
    v_mfma_f32_16x16x32_bf16 v[76:79], v[60:63], v[28:31], v[76:79]
    v_add_f32 v15, v224, v15
    v_mov_b32 v224, v15
    v_mfma_f32_16x16x32_bf16 v[80:83], v[60:63], v[36:39], v[80:83]
    s_nop 0
    v_permlane16_swap_b32 v224, v15
    v_add_f32 v15, v224, v15
    v_mfma_f32_16x16x32_bf16 v[84:87], v[60:63], v[44:47], v[84:87]
    v_mul_f32 v224, v14, v14
    v_add_f32_dpp v15, v15, v15 row_ror:8 row_mask:0xf bank_mask:0xf
    v_mfma_f32_16x16x32_bf16 v[88:91], v[60:63], v[52:55], v[88:91]
    v_fma_f32 v15, v15, s48, -v224
    v_max_f32 v15, 0, v15
    v_add_f32 v15, 0x3727c5ac, v15
    v_rsq_f32 v15, v15
    s_nop 0
    v_pk_mul_f32 v[72:73], v[72:73], v[14:15] op_sel:[0,1] op_sel_hi:[1,1]
    v_pk_mul_f32 v[74:75], v[74:75], v[14:15] op_sel:[0,1] op_sel_hi:[1,1]
    v_cvt_pk_bf16_f32 v72, v72, v73
    v_cvt_pk_bf16_f32 v73, v74, v75
    ds_write_b64 v11, v[72:73] offset:40960
    v_pk_mul_f32 v[76:77], v[76:77], v[14:15] op_sel:[0,1] op_sel_hi:[1,1]
    v_pk_mul_f32 v[78:79], v[78:79], v[14:15] op_sel:[0,1] op_sel_hi:[1,1]
    v_cvt_pk_bf16_f32 v76, v76, v77
    v_cvt_pk_bf16_f32 v77, v78, v79
    ds_write_b64 v11, v[76:77] offset:40992
    v_pk_mul_f32 v[80:81], v[80:81], v[14:15] op_sel:[0,1] op_sel_hi:[1,1]
    v_pk_mul_f32 v[82:83], v[82:83], v[14:15] op_sel:[0,1] op_sel_hi:[1,1]
    v_cvt_pk_bf16_f32 v80, v80, v81
    v_cvt_pk_bf16_f32 v81, v82, v83
    ds_write_b64 v11, v[80:81] offset:41024
    v_pk_mul_f32 v[84:85], v[84:85], v[14:15] op_sel:[0,1] op_sel_hi:[1,1]
    v_pk_mul_f32 v[86:87], v[86:87], v[14:15] op_sel:[0,1] op_sel_hi:[1,1]
    v_cvt_pk_bf16_f32 v84, v84, v85
    v_cvt_pk_bf16_f32 v85, v86, v87
    ds_write_b64 v11, v[84:85] offset:41056
    v_pk_mul_f32 v[88:89], v[88:89], v[14:15] op_sel:[0,1] op_sel_hi:[1,1]
    v_pk_mul_f32 v[90:91], v[90:91], v[14:15] op_sel:[0,1] op_sel_hi:[1,1]
    v_cvt_pk_bf16_f32 v88, v88, v89
    v_cvt_pk_bf16_f32 v89, v90, v91
    ds_write_b64 v11, v[88:89] offset:41088
    s_waitcnt lgkmcnt(0)
    s_barrier
    ds_read_b64_tr_b16 v[16:17], v12 offset:40960
    ds_read_b64_tr_b16 v[18:19], v12 offset:43520
    ds_read_b64_tr_b16 v[20:21], v12 offset:46080
    ds_read_b64_tr_b16 v[22:23], v12 offset:48640
    ds_read_b64_tr_b16 v[24:25], v12 offset:40992
    ds_read_b64_tr_b16 v[26:27], v12 offset:43552
    ds_read_b64_tr_b16 v[28:29], v12 offset:46112
    ds_read_b64_tr_b16 v[30:31], v12 offset:48672
    ds_read_b64_tr_b16 v[32:33], v12 offset:41024
    ds_read_b64_tr_b16 v[34:35], v12 offset:43584
    ds_read_b64_tr_b16 v[36:37], v12 offset:46144
    ds_read_b64_tr_b16 v[38:39], v12 offset:48704
    ds_read_b64_tr_b16 v[40:41], v12 offset:41056
    ds_read_b64_tr_b16 v[42:43], v12 offset:43616
    ds_read_b64_tr_b16 v[44:45], v12 offset:46176
    ds_read_b64_tr_b16 v[46:47], v12 offset:48736
    ds_read_b64_tr_b16 v[48:49], v12 offset:41088
    ds_read_b64_tr_b16 v[50:51], v12 offset:43648
    ds_read_b64_tr_b16 v[52:53], v12 offset:46208
    ds_read_b64_tr_b16 v[54:55], v12 offset:48768
    s_waitcnt lgkmcnt(15)
    v_mfma_f32_16x16x32_bf16 v[92:95], v[16:19], v[64:67], 0
    v_mfma_f32_16x16x32_bf16 v[92:95], v[20:23], v[68:71], v[92:95]
    s_waitcnt lgkmcnt(14)
    v_mfma_f32_16x16x32_bf16 v[96:99], v[24:27], v[64:67], 0
    s_waitcnt lgkmcnt(12)
    v_mfma_f32_16x16x32_bf16 v[96:99], v[28:31], v[68:71], v[96:99]
    s_waitcnt lgkmcnt(10)
    v_mfma_f32_16x16x32_bf16 v[100:103], v[32:35], v[64:67], 0
    s_waitcnt lgkmcnt(8)
    v_mfma_f32_16x16x32_bf16 v[100:103], v[36:39], v[68:71], v[100:103]
    s_waitcnt lgkmcnt(6)
    v_mfma_f32_16x16x32_bf16 v[104:107], v[40:43], v[64:67], 0
    s_waitcnt lgkmcnt(4)
    v_mfma_f32_16x16x32_bf16 v[104:107], v[44:47], v[68:71], v[104:107]
    s_waitcnt lgkmcnt(2)
    v_mfma_f32_16x16x32_bf16 v[108:111], v[48:51], v[64:67], 0
    s_waitcnt lgkmcnt(0)
    v_mfma_f32_16x16x32_bf16 v[108:111], v[52:55], v[68:71], v[108:111]
    s_lshl_b32 s42, s21, 7
    s_add_u32 s42, s42, 7340032
    s_mul_i32 s3, s41, 40960
    s_add_u32 s42, s42, s3
    v_cvt_pk_bf16_f32 v132, v92, v93
    v_cvt_pk_bf16_f32 v133, v94, v95
    v_cvt_pk_bf16_f32 v136, v96, v97
    v_cvt_pk_bf16_f32 v137, v98, v99
    v_xor_b32_dpp v134, v132, v13 quad_perm:[1,0,3,2] row_mask:0xf bank_mask:0xf
    v_xor_b32_dpp v135, v133, v13 quad_perm:[1,0,3,2] row_mask:0xf bank_mask:0xf
    v_and_b32 v233, 7, v1
    v_lshlrev_b32 v233, 2, v233
    v_mfma_f32_16x16x32_bf16 v[172:175], a[0:3], v[132:135], 0
    v_cvt_pk_bf16_f32 v140, v100, v101
    v_cvt_pk_bf16_f32 v141, v102, v103
    v_mfma_f32_16x16x32_bf16 v[176:179], a[20:23], v[132:135], 0
    v_xor_b32_dpp v138, v136, v13 quad_perm:[1,0,3,2] row_mask:0xf bank_mask:0xf
    v_xor_b32_dpp v139, v137, v13 quad_perm:[1,0,3,2] row_mask:0xf bank_mask:0xf
    s_nop 1
    v_mfma_f32_16x16x32_bf16 v[172:175], a[4:7], v[136:139], v[172:175]
    v_cvt_pk_bf16_f32 v144, v104, v105
    v_cvt_pk_bf16_f32 v145, v106, v107
    v_mfma_f32_16x16x32_bf16 v[176:179], a[24:27], v[136:139], v[176:179]
    v_xor_b32_dpp v142, v140, v13 quad_perm:[1,0,3,2] row_mask:0xf bank_mask:0xf
    v_xor_b32_dpp v143, v141, v13 quad_perm:[1,0,3,2] row_mask:0xf bank_mask:0xf
    s_nop 1
    v_mfma_f32_16x16x32_bf16 v[172:175], a[8:11], v[140:143], v[172:175]
    v_cvt_pk_bf16_f32 v148, v108, v109
    v_cvt_pk_bf16_f32 v149, v110, v111
    v_mfma_f32_16x16x32_bf16 v[176:179], a[28:31], v[140:143], v[176:179]
    v_xor_b32_dpp v146, v144, v13 quad_perm:[1,0,3,2] row_mask:0xf bank_mask:0xf
    v_xor_b32_dpp v147, v145, v13 quad_perm:[1,0,3,2] row_mask:0xf bank_mask:0xf
    s_nop 1
    v_mfma_f32_16x16x32_bf16 v[172:175], a[12:15], v[144:147], v[172:175]
    v_xor_b32_dpp v150, v148, v13 quad_perm:[1,0,3,2] row_mask:0xf bank_mask:0xf
    v_xor_b32_dpp v151, v149, v13 quad_perm:[1,0,3,2] row_mask:0xf bank_mask:0xf
    v_mfma_f32_16x16x32_bf16 v[176:179], a[32:35], v[144:147], v[176:179]
    s_bfe_u32 s60, s2, 0x20001
    s_lshl_b32 s60, s60, 2
    v_mfma_f32_16x16x32_bf16 v[172:175], a[16:19], v[148:151], v[172:175]
    s_bfe_u32 s3, s2, 0x20003
    s_add_u32 s60, s60, s3
    v_mfma_f32_16x16x32_bf16 v[176:179], a[36:39], v[148:151], v[176:179]
    s_bfe_u32 s3, s2, 0x10005
    s_lshl_b32 s50, s22, 1
    v_mfma_f32_16x16x32_bf16 v[180:183], a[40:43], v[132:135], 0
    s_add_u32 s50, s50, s3
    s_lshr_b32 s37, s50, 1
    v_mfma_f32_16x16x32_bf16 v[184:187], a[60:63], v[132:135], 0
    s_cmp_eq_u32 s37, 3
    s_cselect_b32 s37, 5, s37
    s_add_u32 s36, s37, 3
    s_lshl_b32 s3, s50, 2
    v_mfma_f32_16x16x32_bf16 v[180:183], a[44:47], v[136:139], v[180:183]
    v_cvt_pk_bf16_f32 v172, v172, v173
    s_lshr_b32 s61, 1985229328, s3
    v_mfma_f32_16x16x32_bf16 v[184:187], a[64:67], v[136:139], v[184:187]
    v_cvt_pk_bf16_f32 v173, v174, v175
    s_lshr_b32 s38, 4275878552, s3
    v_mfma_f32_16x16x32_bf16 v[180:183], a[48:51], v[140:143], v[180:183]
    v_cvt_pk_bf16_f32 v174, v176, v177
    s_bitcmp1_b32 s2, 0
    s_cselect_b32 s37, s37, s36
    s_cselect_b32 s61, s38, s61
    s_cselect_b32 s3, 8, 0
    s_and_b32 s61, s61, 15
    v_mfma_f32_16x16x32_bf16 v[184:187], a[68:71], v[140:143], v[184:187]
    v_cvt_pk_bf16_f32 v175, v178, v179
    s_and_b32 s36, s50, 1
    v_mfma_f32_16x16x32_bf16 v[180:183], a[52:55], v[144:147], v[180:183]
    s_add_u32 s43, s42, 0
    buffer_store_dwordx4 v[172:175], v226, s[8:11], s43 offen sc1
    s_or_b32 s50, s50, s3
    v_mfma_f32_16x16x32_bf16 v[184:187], a[72:75], v[144:147], v[184:187]
    s_sub_u32 s3, 4, s37
    s_cmp_eq_u32 s36, 0
    s_cselect_b32 s38, s37, s3
    s_sub_u32 s3, 32, s60
    v_mfma_f32_16x16x32_bf16 v[180:183], a[56:59], v[148:151], v[180:183]
    s_cmp_eq_u32 s60, 0
    s_cselect_b32 s3, 16, s3
    s_cmp_eq_u32 s36, 0
    s_cselect_b32 s39, s60, s3
    s_lshr_b32 s44, s50, 3
    s_lshl_b32 s44, s44, 2
    v_mfma_f32_16x16x32_bf16 v[184:187], a[76:79], v[148:151], v[184:187]
    s_and_b32 s3, s50, 3
    s_or_b32 s44, s44, s3
    v_mfma_f32_16x16x32_bf16 v[188:191], a[80:83], v[132:135], 0
    s_bfe_u32 s49, s50, 0x10002
    s_and_b32 s3, s60, 3
    v_mfma_f32_16x16x32_bf16 v[188:191], a[84:87], v[136:139], v[188:191]
    s_lshl_b32 s3, s3, 1
    s_add_u32 s49, s49, s3
    v_mfma_f32_16x16x32_bf16 v[188:191], a[88:91], v[140:143], v[188:191]
    v_cvt_pk_bf16_f32 v180, v180, v181
    s_lshl_b32 s35, s20, 9
    v_mfma_f32_16x16x32_bf16 v[188:191], a[92:95], v[144:147], v[188:191]
    v_cvt_pk_bf16_f32 v181, v182, v183
    s_add_u32 s35, s35, s39
    v_mfma_f32_16x16x32_bf16 v[188:191], a[96:99], v[148:151], v[188:191]
    v_cvt_pk_bf16_f32 v182, v184, v185
    s_mul_i32 s35, s35, 1280
    v_cvt_pk_bf16_f32 v183, v186, v187
    s_add_u32 s43, s42, 8192
    buffer_store_dwordx4 v[180:183], v227, s[8:11], s43 offen sc1
    s_nop 2
    v_cvt_pk_bf16_f32 v188, v188, v189
    v_cvt_pk_bf16_f32 v189, v190, v191
    buffer_load_dword v225, v233, s[56:59], 0 offen sc1
    s_add_u32 s43, s42, 16384
    buffer_store_dwordx2 v[188:189], v229, s[8:11], s43 offen sc1
    s_lshl_b32 s3, s38, 8
    s_add_u32 s35, s35, s3
    s_lshl_b32 s54, s20, 12
    s_add_u32 s54, s54, 147456
    s_mul_i32 s30, s61, 7
    s_mul_i32 s3, s61, 6
    s_add_u32 s3, s3, 12
    s_cmp_le_u32 s61, 11
    s_cselect_b32 s30, s30, s3
    s_cselect_b32 s47, 14, 12
    s_and_b32 s31, s30, 1
    s_lshl_b32 s32, s30, 5
    s_mul_i32 s3, s20, 110592
    s_add_u32 s32, s32, s3
    s_mul_i32 s55, s20, 7168
    s_movk_i32 s3, 3456
    s_mul_i32 s46, s44, 56
    s_mul_i32 s3, s20, 14
    s_add_u32 s46, s46, s3
    s_mul_i32 s46, s46, 5120
    s_add_u32 s46, s46, 4194304
    s_cmp_eq_u32 s20, 3
    s_cselect_b32 s47, 12, 14
    v_mul_u32_u24 v167, 40960, v2
    v_xor_b32 v8, v3, v2
    v_lshl_add_u32 v167, v8, 4, v167
    v_accvgpr_read_b32 v160, a240
    v_accvgpr_read_b32 v161, a241
    v_accvgpr_read_b32 v162, a242
    v_accvgpr_read_b32 v163, a243
    v_accvgpr_read_b32 v164, a244
    v_accvgpr_read_b32 v165, a245
    v_accvgpr_read_b32 v166, a246
    s_mov_b32 s53, 3
    s_mul_i32 s33, s53, 442368
    s_add_u32 s33, s33, s32
    s_mul_i32 s53, s53, 28672
    s_add_u32 s53, s53, s55
    s_add_u32 m0, s53, 0
    s_nop 0
    buffer_load_dwordx4 v160, s[24:27], s33 offen  lds
    s_add_u32 m0, s53, 1024
    s_nop 0
    buffer_load_dwordx4 v161, s[24:27], s33 offen  lds
    s_add_u32 m0, s53, 2048
    s_nop 0
    buffer_load_dwordx4 v162, s[24:27], s33 offen  lds
    s_cmp_lt_u32 s37, 5
    s_cbranch_scc0 Lopt5
    s_add_u32 m0, s54, 0
    s_nop 0
    buffer_load_dwordx4 v167, s[4:7], s35 offen  lds
    s_add_u32 s35, s35, 163840
    v_xor_b32 v167, 64, v167
    s_add_u32 m0, s54, 1024
    s_nop 0
    buffer_load_dwordx4 v167, s[4:7], s35 offen  lds
    s_add_u32 s35, s35, 163840
    v_xor_b32 v167, 192, v167
    s_add_u32 m0, s54, 2048
    s_nop 0
    buffer_load_dwordx4 v167, s[4:7], s35 offen  lds
    s_add_u32 s35, s35, 163840
    v_xor_b32 v167, 64, v167
    s_add_u32 m0, s54, 3072
    s_nop 0
    buffer_load_dwordx4 v167, s[4:7], s35 offen  lds
Lopt5:
    s_mov_b32 s100, s33
    s_mov_b32 s41, 2147483648
    s_lshr_b32 s35, s2, 1
    s_add_u32 s35, s35, 32
    s_cmp_lt_u32 s2, 64
    s_cselect_b32 s35, s2, s35
    s_cmp_lt_u32 s37, 5
    s_cselect_b32 s35, 112, s35
    s_cmp_ge_u32 s35, 112
    s_cbranch_scc1 Lnotask6
    s_bfe_u32 s62, s35, 0x20001
    s_lshr_b32 s63, s35, 3
    s_and_b32 s35, s35, 1
    s_mov_b32 s0, 3414643728
    s_mov_b32 s1, 14246563
    s_mov_b32 s28, 2843099920
    s_mov_b32 s29, 12079871
    s_cmp_lt_u32 s62, 3
    s_cselect_b64 s[0:1], s[0:1], s[28:29]
    s_lshl_b32 s3, s63, 2
    s_lshr_b64 s[0:1], s[0:1], s3
    s_and_b32 s0, s0, 15
    s_cmp_eq_u32 s0, 15
    s_cbranch_scc1 Lnotask6
    s_mul_i32 s34, s62, 14
    s_add_u32 s0, s0, s34
    s_lshl_b32 s0, s0, 2
    s_add_u32 s0, s0, s20
    s_mul_i32 s33, s0, 10240
    s_lshl_b32 s3, s35, 7
    s_add_u32 s1, s33, s3
    s_add_u32 s1, s1, 1024
    s_lshl_b32 s3, s35, 9
    s_add_u32 s33, s33, s3
    s_lshl_b32 s35, s35, 2
    s_add_u32 s35, s35, s20
    s_mul_i32 s40, s35, 56
    s_add_u32 s40, s40, s34
    s_add_u32 s40, s40, s63
    s_mul_i32 s40, s40, 5120
    s_add_u32 s40, s40, 4194304
    s_lshl_b32 s41, s35, 2
    s_add_u32 s41, s41, s62
    s_add_u32 s41, s41, 160
    s_lshl_b32 s41, s41, 8
    s_mul_i32 s34, s20, 5120
    s_add_u32 s34, s34, 122880
    v_lshrrev_b32 v6, 3, v1
    v_mul_u32_u24 v6, 1280, v6
    v_and_b32 v8, 7, v1
    v_lshl_add_u32 v6, v8, 4, v6
    s_add_u32 m0, s34, 0
    s_nop 0
    buffer_load_dwordx4 v6, s[12:15], s33 offen offset:0  lds
    s_add_u32 m0, s34, 896
    s_nop 0
    buffer_load_dwordx4 v6, s[12:15], s33 offen offset:128  lds
    s_add_u32 m0, s34, 1792
    s_nop 0
    buffer_load_dwordx4 v6, s[12:15], s33 offen offset:256  lds
    s_add_u32 m0, s34, 2688
    s_nop 0
    buffer_load_dwordx4 v6, s[12:15], s33 offen offset:384  lds
    s_add_u32 m0, s34, 4096
    s_nop 0
    buffer_load_dwordx4 v6, s[12:15], s1 offen  lds
Lnotask6:
    s_mov_b32 s43, 2147483648
    s_lshr_b32 s35, s2, 1
    s_add_u32 s35, s35, 64
    s_cmp_lt_u32 s2, 64
    s_cselect_b32 s35, 112, s35
    s_cmp_lt_u32 s37, 5
    s_cselect_b32 s35, 112, s35
    s_cmp_ge_u32 s35, 112
    s_cbranch_scc1 Lnotask7
    s_bfe_u32 s62, s35, 0x20001
    s_lshr_b32 s63, s35, 3
    s_and_b32 s35, s35, 1
    s_mov_b32 s0, 3414643728
    s_mov_b32 s1, 14246563
    s_mov_b32 s28, 2843099920
    s_mov_b32 s29, 12079871
    s_cmp_lt_u32 s62, 3
    s_cselect_b64 s[0:1], s[0:1], s[28:29]
    s_lshl_b32 s3, s63, 2
    s_lshr_b64 s[0:1], s[0:1], s3
    s_and_b32 s0, s0, 15
    s_cmp_eq_u32 s0, 15
    s_cbranch_scc1 Lnotask7
    s_mul_i32 s34, s62, 14
    s_add_u32 s0, s0, s34
    s_lshl_b32 s0, s0, 2
    s_add_u32 s0, s0, s20
    s_mul_i32 s33, s0, 10240
    s_lshl_b32 s3, s35, 7
    s_add_u32 s1, s33, s3
    s_add_u32 s1, s1, 1024
    s_lshl_b32 s3, s35, 9
    s_add_u32 s33, s33, s3
    s_lshl_b32 s35, s35, 2
    s_add_u32 s35, s35, s20
    s_mul_i32 s42, s35, 56
    s_add_u32 s42, s42, s34
    s_add_u32 s42, s42, s63
    s_mul_i32 s42, s42, 5120
    s_add_u32 s42, s42, 4194304
    s_lshl_b32 s43, s35, 2
    s_add_u32 s43, s43, s62
    s_add_u32 s43, s43, 160
    s_lshl_b32 s43, s43, 8
    s_mul_i32 s34, s20, 5120
    s_add_u32 s34, s34, 143360
    v_lshrrev_b32 v6, 3, v1
    v_mul_u32_u24 v6, 1280, v6
    v_and_b32 v8, 7, v1
    v_lshl_add_u32 v6, v8, 4, v6
    s_add_u32 m0, s34, 0
    s_nop 0
    buffer_load_dwordx4 v6, s[12:15], s33 offen offset:0  lds
    s_add_u32 m0, s34, 896
    s_nop 0
    buffer_load_dwordx4 v6, s[12:15], s33 offen offset:128  lds
    s_add_u32 m0, s34, 1792
    s_nop 0
    buffer_load_dwordx4 v6, s[12:15], s33 offen offset:256  lds
    s_add_u32 m0, s34, 2688
    s_nop 0
    buffer_load_dwordx4 v6, s[12:15], s33 offen offset:384  lds
    s_add_u32 m0, s34, 4096
    s_nop 0
    buffer_load_dwordx4 v6, s[12:15], s1 offen  lds
Lnotask7:
    s_mov_b32 s33, s100
    s_add_u32 m0, s53, 3072
    s_nop 0
    buffer_load_dwordx4 v163, s[24:27], s33 offen  lds
    s_add_u32 m0, s53, 4096
    s_nop 0
    buffer_load_dwordx4 v164, s[24:27], s33 offen  lds
    s_add_u32 m0, s53, 5120
    s_nop 0
    buffer_load_dwordx4 v165, s[24:27], s33 offen  lds
    s_bfe_u32 s3, s2, 0x40003
    v_lshl_add_u32 v12, v1, 4, s3
    v_lshlrev_b32 v12, 8, v12
    s_lshl_b32 s3, s44, 2
    s_add_u32 s3, s3, s20
    s_add_u32 s3, s3, 160
    s_lshl_b32 s3, s3, 8
    v_mov_b32 v11, s3
    s_cmp_ge_u32 s37, 5
    s_cbranch_scc0 Lopt8
    s_waitcnt vmcnt(11)
Lopt8:
    s_cmp_lt_u32 s37, 5
    s_cbranch_scc0 Lopt9
    s_waitcnt vmcnt(10)
Lopt9:
    s_cmp_lt_u32 s37, 5
    s_cselect_b32 s3, 0, s41
    s_cmp_eq_u32 s3, 2147483648
    s_cbranch_scc0 Lopt10
    s_waitcnt vmcnt(6)
Lopt10:
    v_cmp_ne_u32 vcc, 1, v225
    s_cbranch_vccz Lok11
    s_mov_b64 exec, 0xff
    s_mov_b32 s63, 100000
Lpoll12:
    buffer_load_dword v225, v233, s[56:59], 0 offen sc1
    s_sub_u32 s63, s63, 1
    s_cbranch_scc1 Lpolld13
    s_waitcnt vmcnt(0)
    v_cmp_ne_u32 vcc, 1, v225
    s_cbranch_vccz Lpolld13
    s_sleep 2
    s_branch Lpoll12
Lpolld13:
    s_waitcnt vmcnt(0)
    s_mov_b64 exec, -1
Lok11:
    s_barrier
    s_cmp_eq_u32 s20, 0
    s_cbranch_scc0 Lopt14
    s_mov_b64 exec, 0xff
    buffer_atomic_add v5, v12, s[8:11], 0 offen sc1
    s_mov_b64 exec, -1
Lopt14:
    s_branch LA_end
LA_second:
    v_cvt_f32_u32 v112, v2
    v_fmaak_f32 v112, 4.0, v112, 0x42800000
    v_add_f32 v113, 1.0, v112
    v_add_f32 v114, 2.0, v112
    v_add_f32 v115, 1.0, v114
    v_and_b32 v7, 3, v3
    v_mad_u32_u24 v7, v242, 8, v7
    v_mad_u32_u24 v7, v241, 64, v7
    v_lshl_add_u32 v7, v7, 3, s41
    v_cvt_f32_u32 v7, v7
    v_mul_f32 v7, 0x3acccccd, v7
    v_add_f32 v6, 0x0, v7
    v_pk_mul_f32 v[244:245], v[234:235], v[6:7] op_sel_hi:[1,0]
    v_pk_mul_f32 v[246:247], v[236:237], v[6:7] op_sel_hi:[1,0]
    v_cos_f32 v248, v244
    v_sin_f32 v252, v244
    v_cos_f32 v249, v245
    v_sin_f32 v253, v245
    v_cos_f32 v250, v246
    v_sin_f32 v254, v246
    v_cos_f32 v251, v247
    v_sin_f32 v255, v247
    v_cvt_pk_bf16_f32 v92, v248, v249
    v_cvt_pk_bf16_f32 v93, v250, v251
    v_cvt_pk_bf16_f32 v94, v252, v253
    v_cvt_pk_bf16_f32 v95, v254, v255
    ds_write_b128 v239, v[92:95] offset:0
    v_add_f32 v6, 0x3d4ccccd, v7
    v_pk_mul_f32 v[244:245], v[234:235], v[6:7] op_sel_hi:[1,0]
    v_pk_mul_f32 v[246:247], v[236:237], v[6:7] op_sel_hi:[1,0]
    v_cos_f32 v248, v244
    v_sin_f32 v252, v244
    v_cos_f32 v249, v245
    v_sin_f32 v253, v245
    v_cos_f32 v250, v246
    v_sin_f32 v254, v246
    v_cos_f32 v251, v247
    v_sin_f32 v255, v247
    v_cvt_pk_bf16_f32 v96, v248, v249
    v_cvt_pk_bf16_f32 v97, v250, v251
    v_cvt_pk_bf16_f32 v98, v252, v253
    v_cvt_pk_bf16_f32 v99, v254, v255
    ds_write_b128 v239, v[96:99] offset:5120
    s_lshl_b32 s3, s20, 3
    s_lshr_b32 s42, 538984512, s3
    s_and_b32 s42, s42, 255
    s_lshr_b32 s43, 134744072, s3
    s_and_b32 s43, s43, 255
    s_lshr_b32 s44, 673187840, s3
    s_and_b32 s44, s44, 255
    s_lshl_b32 s44, s44, 2
    s_add_u32 s44, s44, s41
    s_mul_i32 s45, s20, 5120
    v_and_b32 v6, 3, v3
    v_mad_u32_u24 v6, v242, s43, v6
    v_mad_u32_u24 v6, v241, s42, v6
    v_lshl_add_u32 v6, v6, 3, s44
    v_cvt_f32_u32 v6, v6
    v_mul_f32 v6, 0x3acccccd, v6
    v_add_u32 v240, s45, v4
    v_pk_mul_f32 v[244:245], v[112:113], v[6:7] op_sel_hi:[1,0]
    v_pk_mul_f32 v[246:247], v[114:115], v[6:7] op_sel_hi:[1,0]
    v_cos_f32 v248, v244
    v_sin_f32 v252, v244
    v_cos_f32 v249, v245
    v_sin_f32 v253, v245
    v_cos_f32 v250, v246
    v_sin_f32 v254, v246
    v_cos_f32 v251, v247
    v_sin_f32 v255, v247
    v_cvt_pk_bf16_f32 v100, v248, v249
    v_cvt_pk_bf16_f32 v101, v250, v251
    v_cvt_pk_bf16_f32 v102, v252, v253
    v_cvt_pk_bf16_f32 v103, v254, v255
    ds_write_b128 v240, v[100:103] offset:4096
    v_and_b32 v7, 3, v3
    v_mad_u32_u24 v7, v242, 8, v7
    v_mad_u32_u24 v7, v241, 32, v7
    v_lshl_add_u32 v7, v7, 3, s41
    v_cvt_f32_u32 v7, v7
    v_mul_f32 v7, 0x3acccccd, v7
    v_add_f32 v6, 0x3e4ccccd, v7
    v_pk_mul_f32 v[244:245], v[234:235], v[6:7] op_sel_hi:[1,0]
    v_pk_mul_f32 v[246:247], v[236:237], v[6:7] op_sel_hi:[1,0]
    v_cos_f32 v248, v244
    v_sin_f32 v252, v244
    v_cos_f32 v249, v245
    v_sin_f32 v253, v245
    v_cos_f32 v250, v246
    v_sin_f32 v254, v246
    v_cos_f32 v251, v247
    v_sin_f32 v255, v247
    v_cvt_pk_bf16_f32 v92, v248, v249
    v_cvt_pk_bf16_f32 v93, v250, v251
    v_cvt_pk_bf16_f32 v94, v252, v253
    v_cvt_pk_bf16_f32 v95, v254, v255
    ds_write_b128 v239, v[92:95] offset:10240
    v_add_f32 v6, 0x3e800000, v7
    v_pk_mul_f32 v[244:245], v[234:235], v[6:7] op_sel_hi:[1,0]
    v_pk_mul_f32 v[246:247], v[236:237], v[6:7] op_sel_hi:[1,0]
    v_cos_f32 v248, v244
    v_sin_f32 v252, v244
    v_cos_f32 v249, v245
    v_sin_f32 v253, v245
    v_cos_f32 v250, v246
    v_sin_f32 v254, v246
    v_cos_f32 v251, v247
    v_sin_f32 v255, v247
    v_cvt_pk_bf16_f32 v96, v248, v249
    v_cvt_pk_bf16_f32 v97, v250, v251
    v_cvt_pk_bf16_f32 v98, v252, v253
    v_cvt_pk_bf16_f32 v99, v254, v255
    ds_write_b128 v239, v[96:99] offset:15360
    s_lshl_b32 s3, s20, 3
    s_lshr_b32 s42, 135270408, s3
    s_and_b32 s42, s42, 255
    s_lshr_b32 s43, 67635204, s3
    s_and_b32 s43, s43, 255
    s_lshr_b32 s44, 1091109184, s3
    s_and_b32 s44, s44, 255
    s_lshl_b32 s44, s44, 2
    s_add_u32 s44, s44, s41
    s_mul_i32 s45, s20, 5120
    v_and_b32 v6, 3, v3
    v_mad_u32_u24 v6, v242, s43, v6
    v_mad_u32_u24 v6, v241, s42, v6
    v_lshl_add_u32 v6, v6, 3, s44
    v_cvt_f32_u32 v6, v6
    v_mul_f32 v6, 0x3acccccd, v6
    v_add_u32 v240, s45, v4
    v_pk_mul_f32 v[244:245], v[112:113], v[6:7] op_sel_hi:[1,0]
    v_pk_mul_f32 v[246:247], v[114:115], v[6:7] op_sel_hi:[1,0]
    v_cos_f32 v248, v244
    v_sin_f32 v252, v244
    v_cos_f32 v249, v245
    v_sin_f32 v253, v245
    v_cos_f32 v250, v246
    v_sin_f32 v254, v246
    v_cos_f32 v251, v247
    v_sin_f32 v255, v247
    v_cvt_pk_bf16_f32 v100, v248, v249
    v_cvt_pk_bf16_f32 v101, v250, v251
    v_cvt_pk_bf16_f32 v102, v252, v253
    v_cvt_pk_bf16_f32 v103, v254, v255
    ds_write_b128 v240, v[100:103] offset:24576
Lls15:
    v_and_b32 v7, 3, v3
    v_mad_u32_u24 v7, v242, 4, v7
    v_mad_u32_u24 v7, v241, 8, v7
    v_lshl_add_u32 v7, v7, 3, s41
    v_cvt_f32_u32 v7, v7
    v_mul_f32 v7, 0x3acccccd, v7
    v_add_f32 v6, 0x3ecccccd, v7
    v_pk_mul_f32 v[244:245], v[234:235], v[6:7] op_sel_hi:[1,0]
    v_pk_mul_f32 v[246:247], v[236:237], v[6:7] op_sel_hi:[1,0]
    v_cos_f32 v248, v244
    v_sin_f32 v252, v244
    v_cos_f32 v249, v245
    v_sin_f32 v253, v245
    v_cos_f32 v250, v246
    v_sin_f32 v254, v246
    v_cos_f32 v251, v247
    v_sin_f32 v255, v247
    v_cvt_pk_bf16_f32 v92, v248, v249
    v_cvt_pk_bf16_f32 v93, v250, v251
    v_cvt_pk_bf16_f32 v94, v252, v253
    v_cvt_pk_bf16_f32 v95, v254, v255
    ds_write_b128 v239, v[92:95] offset:20480
    s_cmp_ge_u32 s50, 8
    s_cbranch_scc1 Lrdy16
    s_waitcnt vmcnt(12)
    s_lshl_b32 s3, s2, 2
    s_mov_b64 exec, 1
    buffer_store_dword v5, v233, s[56:59], s3 offen sc1
    s_mov_b64 exec, -1
Lrdy16:
    v_and_b32 v7, 3, v3
    v_mad_u32_u24 v7, v242, 8, v7
    v_mad_u32_u24 v7, v241, 16, v7
    v_lshl_add_u32 v7, v7, 3, s41
    v_cvt_f32_u32 v7, v7
    v_mul_f32 v7, 0x3acccccd, v7
    v_add_f32 v6, 0x3bcccccd, v7
    v_pk_mul_f32 v[244:245], v[234:235], v[6:7] op_sel_hi:[1,0]
    v_pk_mul_f32 v[246:247], v[236:237], v[6:7] op_sel_hi:[1,0]
    v_cos_f32 v248, v244
    v_sin_f32 v252, v244
    v_cos_f32 v249, v245
    v_sin_f32 v253, v245
    v_cos_f32 v250, v246
    v_sin_f32 v254, v246
    v_cos_f32 v251, v247
    v_sin_f32 v255, v247
    v_cvt_pk_bf16_f32 v96, v248, v249
    v_cvt_pk_bf16_f32 v97, v250, v251
    v_cvt_pk_bf16_f32 v98, v252, v253
    v_cvt_pk_bf16_f32 v99, v254, v255
    ds_write_b128 v239, v[96:99] offset:25600
    v_add_f32 v6, 0x3d666666, v7
    v_pk_mul_f32 v[244:245], v[234:235], v[6:7] op_sel_hi:[1,0]
    v_pk_mul_f32 v[246:247], v[236:237], v[6:7] op_sel_hi:[1,0]
    v_cos_f32 v248, v244
    v_sin_f32 v252, v244
    v_cos_f32 v249, v245
    v_sin_f32 v253, v245
    v_cos_f32 v250, v246
    v_sin_f32 v254, v246
    v_cos_f32 v251, v247
    v_sin_f32 v255, v247
    v_cvt_pk_bf16_f32 v92, v248, v249
    v_cvt_pk_bf16_f32 v93, v250, v251
    v_cvt_pk_bf16_f32 v94, v252, v253
    v_cvt_pk_bf16_f32 v95, v254, v255
    ds_write_b128 v239, v[92:95] offset:30720
    v_and_b32 v7, 3, v3
    v_mad_u32_u24 v7, v242, 4, v7
    v_mad_u32_u24 v7, v241, 8, v7
    v_lshl_add_u32 v7, v7, 3, s41
    v_cvt_f32_u32 v7, v7
    v_mul_f32 v7, 0x3acccccd, v7
    v_add_f32 v6, 0x3ed00000, v7
    v_pk_mul_f32 v[244:245], v[234:235], v[6:7] op_sel_hi:[1,0]
    v_pk_mul_f32 v[246:247], v[236:237], v[6:7] op_sel_hi:[1,0]
    v_cos_f32 v248, v244
    v_sin_f32 v252, v244
    v_cos_f32 v249, v245
    v_sin_f32 v253, v245
    v_cos_f32 v250, v246
    v_sin_f32 v254, v246
    v_cos_f32 v251, v247
    v_sin_f32 v255, v247
    v_cvt_pk_bf16_f32 v96, v248, v249
    v_cvt_pk_bf16_f32 v97, v250, v251
    v_cvt_pk_bf16_f32 v98, v252, v253
    v_cvt_pk_bf16_f32 v99, v254, v255
    ds_write_b128 v239, v[96:99] offset:35840
    v_sub_u32 v6, v3, v2
    v_mad_i32_i24 v6, v2, -3, v6
    v_cmp_eq_u32 s[0:1], 0, v6
    v_cmp_eq_u32 s[62:63], 1, v6
    v_cmp_eq_u32 s[100:101], 2, v6
    v_cmp_eq_u32 s[28:29], 3, v6
    s_mov_b32 s48, 0x3acccccd
    v_mov_b32 v100, s51
    v_mov_b32 v101, s51
    v_mov_b32 v102, s51
    v_mov_b32 v103, s51
    s_waitcnt lgkmcnt(0)
    s_barrier
    s_waitcnt vmcnt(0)
    ds_read_b128 v[16:19], v172 offset:0
    ds_read_b128 v[20:23], v172 offset:20480
    ds_read_b128 v[24:27], v173 offset:0
    ds_read_b128 v[28:31], v173 offset:20480
    ds_read_b128 v[32:35], v174 offset:0
    ds_read_b128 v[36:39], v174 offset:20480
    ds_read_b128 v[40:43], v175 offset:0
    ds_read_b128 v[44:47], v175 offset:20480
    ds_read_b128 v[48:51], v176 offset:0
    ds_read_b128 v[52:55], v176 offset:20480
    s_lshl_b32 s3, s2, 2
    s_add_u32 s3, s3, s20
    s_mul_i32 s3, s3, 2176
    v_lshlrev_b32 v8, 7, v1
    s_bfm_b64 exec, 17, 0
    buffer_load_dword a254, v8, s[24:27], s3 offen
    buffer_load_dword a253, v8, s[12:15], s3 offen
    s_lshl_b32 s3, s2, 2
    s_add_u32 s3, s3, s20
    s_mul_i32 s3, s3, 2560
    s_mov_b64 exec, 0xc0300
    buffer_load_dword a248, v8, s[16:19], s3 offen
    s_mov_b64 exec, -1
    s_waitcnt lgkmcnt(9)
    v_mfma_f32_16x16x32_bf16 v[92:95], v[16:19], v[16:19], 0
    ds_read_b128 a[0:3], v4 offset:0
    v_mfma_f32_16x16x32_bf16 v[96:99], v[100:103], v[16:19], 0
    s_waitcnt lgkmcnt(9)
    v_mfma_f32_16x16x32_bf16 v[92:95], v[20:23], v[20:23], v[92:95]
    ds_read_b128 a[4:7], v4 offset:1024
    v_mfma_f32_16x16x32_bf16 v[96:99], v[100:103], v[20:23], v[96:99]
    s_waitcnt lgkmcnt(9)
    v_mfma_f32_16x16x32_bf16 v[92:95], v[24:27], v[24:27], v[92:95]
    ds_read_b128 a[8:11], v4 offset:2048
    v_mfma_f32_16x16x32_bf16 v[96:99], v[100:103], v[24:27], v[96:99]
    s_waitcnt lgkmcnt(9)
    v_mfma_f32_16x16x32_bf16 v[92:95], v[28:31], v[28:31], v[92:95]
    ds_read_b128 a[12:15], v4 offset:3072
    v_mfma_f32_16x16x32_bf16 v[96:99], v[100:103], v[28:31], v[96:99]
    ds_read_b128 a[16:19], v4 offset:4096
    s_waitcnt lgkmcnt(10)
    v_mfma_f32_16x16x32_bf16 v[92:95], v[32:35], v[32:35], v[92:95]
    ds_read_b128 a[20:23], v4 offset:5120
    v_mfma_f32_16x16x32_bf16 v[96:99], v[100:103], v[32:35], v[96:99]
    ds_read_b128 a[24:27], v4 offset:6144
    s_waitcnt lgkmcnt(11)
    v_mfma_f32_16x16x32_bf16 v[92:95], v[36:39], v[36:39], v[92:95]
    ds_read_b128 a[28:31], v4 offset:7168
    v_mfma_f32_16x16x32_bf16 v[96:99], v[100:103], v[36:39], v[96:99]
    ds_read_b128 a[32:35], v4 offset:8192
    s_waitcnt lgkmcnt(12)
    v_mfma_f32_16x16x32_bf16 v[92:95], v[40:43], v[40:43], v[92:95]
    ds_read_b128 a[36:39], v4 offset:9216
    v_mfma_f32_16x16x32_bf16 v[96:99], v[100:103], v[40:43], v[96:99]
    ds_read_b128 a[40:43], v4 offset:10240
    s_waitcnt lgkmcnt(13)
    v_mfma_f32_16x16x32_bf16 v[92:95], v[44:47], v[44:47], v[92:95]
    ds_read_b128 a[44:47], v4 offset:11264
    v_mfma_f32_16x16x32_bf16 v[96:99], v[100:103], v[44:47], v[96:99]
    ds_read_b128 a[48:51], v4 offset:12288
    s_waitcnt lgkmcnt(14)
    v_mfma_f32_16x16x32_bf16 v[92:95], v[48:51], v[48:51], v[92:95]
    ds_read_b128 a[52:55], v4 offset:13312
    v_mfma_f32_16x16x32_bf16 v[96:99], v[100:103], v[48:51], v[96:99]
    ds_read_b128 a[56:59], v4 offset:14336
    s_waitcnt lgkmcnt(15)
    v_mfma_f32_16x16x32_bf16 v[92:95], v[52:55], v[52:55], v[92:95]
    ds_read_b128 a[60:63], v4 offset:15360
    v_mfma_f32_16x16x32_bf16 v[96:99], v[100:103], v[52:55], v[96:99]
    ds_read_b128 a[64:67], v4 offset:16384
    v_mfma_f32_16x16x32_bf16 v[72:75], v[56:59], v[16:19], 0
    v_mfma_f32_16x16x32_bf16 v[76:79], v[56:59], v[24:27], 0
    v_mfma_f32_16x16x32_bf16 v[80:83], v[56:59], v[32:35], 0
    ds_read_b128 a[68:71], v4 offset:17408
    ds_read_b128 a[72:75], v4 offset:18432
    ds_read_b128 a[76:79], v4 offset:19456
    ds_read_b128 a[80:83], v4 offset:20480
    ds_read_b128 a[84:87], v4 offset:21504
    ds_read_b128 a[88:91], v4 offset:22528
    ds_read_b128 a[92:95], v4 offset:23552
    ds_read_b128 a[96:99], v4 offset:24576
    v_cndmask_b32 v15, 0, v92, s[0:1]
    v_cndmask_b32 v15, v15, v93, s[62:63]
    v_mfma_f32_16x16x32_bf16 v[84:87], v[56:59], v[40:43], 0
    v_cndmask_b32 v15, v15, v94, s[100:101]
    v_cndmask_b32 v15, v15, v95, s[28:29]
    v_mfma_f32_16x16x32_bf16 v[88:91], v[56:59], v[48:51], 0
    v_add_f32_dpp v14, v96, v96 row_ror:8 row_mask:0xf bank_mask:0xf
    v_mov_b32 v224, v15
    v_mfma_f32_16x16x32_bf16 v[72:75], v[60:63], v[20:23], v[72:75]
    v_mul_f32 v14, 0x3acccccd, v14
    v_permlane32_swap_b32 v224, v15
    v_mfma_f32_16x16x32_bf16 v[76:79], v[60:63], v[28:31], v[76:79]
    v_add_f32 v15, v224, v15
    v_mov_b32 v224, v15
    v_mfma_f32_16x16x32_bf16 v[80:83], v[60:63], v[36:39], v[80:83]
    s_nop 0
    v_permlane16_swap_b32 v224, v15
    v_add_f32 v15, v224, v15
    v_mfma_f32_16x16x32_bf16 v[84:87], v[60:63], v[44:47], v[84:87]
    v_mul_f32 v224, v14, v14
    v_add_f32_dpp v15, v15, v15 row_ror:8 row_mask:0xf bank_mask:0xf
    v_mfma_f32_16x16x32_bf16 v[88:91], v[60:63], v[52:55], v[88:91]
    v_fma_f32 v15, v15, s48, -v224
    v_max_f32 v15, 0, v15
    v_add_f32 v15, 0x3727c5ac, v15
    v_rsq_f32 v15, v15
    v_cmp_gt_u32 vcc, 32, v1
    v_cvt_pk_bf16_f32 v224, v14, v14
    v_lshlrev_b32 v14, 16, v224
    v_mul_f32 v14, 0xc1000000, v14
    v_mul_f32 v14, v14, v15
    v_cndmask_b32 v14, 0, v14, vcc
    v_pk_fma_f32 v[72:73], v[72:73], v[14:15], v[14:15] op_sel:[0,1,0] op_sel_hi:[1,1,0]
    v_pk_fma_f32 v[74:75], v[74:75], v[14:15], v[14:15] op_sel:[0,1,0] op_sel_hi:[1,1,0]
    v_cvt_pk_bf16_f32 v72, v72, v73
    v_cvt_pk_bf16_f32 v73, v74, v75
    ds_write_b64 v11, v[72:73] offset:40960
    v_pk_fma_f32 v[76:77], v[76:77], v[14:15], v[14:15] op_sel:[0,1,0] op_sel_hi:[1,1,0]
    v_pk_fma_f32 v[78:79], v[78:79], v[14:15], v[14:15] op_sel:[0,1,0] op_sel_hi:[1,1,0]
    v_cvt_pk_bf16_f32 v76, v76, v77
    v_cvt_pk_bf16_f32 v77, v78, v79
    ds_write_b64 v11, v[76:77] offset:40992
    v_pk_fma_f32 v[80:81], v[80:81], v[14:15], v[14:15] op_sel:[0,1,0] op_sel_hi:[1,1,0]
    v_pk_fma_f32 v[82:83], v[82:83], v[14:15], v[14:15] op_sel:[0,1,0] op_sel_hi:[1,1,0]
    v_cvt_pk_bf16_f32 v80, v80, v81
    v_cvt_pk_bf16_f32 v81, v82, v83
    ds_write_b64 v11, v[80:81] offset:41024
    v_pk_fma_f32 v[84:85], v[84:85], v[14:15], v[14:15] op_sel:[0,1,0] op_sel_hi:[1,1,0]
    v_pk_fma_f32 v[86:87], v[86:87], v[14:15], v[14:15] op_sel:[0,1,0] op_sel_hi:[1,1,0]
    v_cvt_pk_bf16_f32 v84, v84, v85
    v_cvt_pk_bf16_f32 v85, v86, v87
    ds_write_b64 v11, v[84:85] offset:41056
    v_pk_fma_f32 v[88:89], v[88:89], v[14:15], v[14:15] op_sel:[0,1,0] op_sel_hi:[1,1,0]
    v_pk_fma_f32 v[90:91], v[90:91], v[14:15], v[14:15] op_sel:[0,1,0] op_sel_hi:[1,1,0]
    v_cvt_pk_bf16_f32 v88, v88, v89
    v_cvt_pk_bf16_f32 v89, v90, v91
    ds_write_b64 v11, v[88:89] offset:41088
    s_waitcnt lgkmcnt(0)
    s_barrier
    ds_read_b64_tr_b16 v[16:17], v12 offset:40960
    ds_read_b64_tr_b16 v[18:19], v12 offset:43520
    ds_read_b64_tr_b16 v[20:21], v12 offset:46080
    ds_read_b64_tr_b16 v[22:23], v12 offset:48640
    ds_read_b64_tr_b16 v[24:25], v12 offset:40992
    ds_read_b64_tr_b16 v[26:27], v12 offset:43552
    ds_read_b64_tr_b16 v[28:29], v12 offset:46112
    ds_read_b64_tr_b16 v[30:31], v12 offset:48672
    ds_read_b64_tr_b16 v[32:33], v12 offset:41024
    ds_read_b64_tr_b16 v[34:35], v12 offset:43584
    ds_read_b64_tr_b16 v[36:37], v12 offset:46144
    ds_read_b64_tr_b16 v[38:39], v12 offset:48704
    ds_read_b64_tr_b16 v[40:41], v12 offset:41056
    ds_read_b64_tr_b16 v[42:43], v12 offset:43616
    ds_read_b64_tr_b16 v[44:45], v12 offset:46176
    ds_read_b64_tr_b16 v[46:47], v12 offset:48736
    ds_read_b64_tr_b16 v[48:49], v12 offset:41088
    ds_read_b64_tr_b16 v[50:51], v12 offset:43648
    ds_read_b64_tr_b16 v[52:53], v12 offset:46208
    ds_read_b64_tr_b16 v[54:55], v12 offset:48768
    s_waitcnt lgkmcnt(15)
    v_mfma_f32_16x16x32_bf16 v[92:95], v[16:19], v[64:67], 0
    v_mfma_f32_16x16x32_bf16 v[112:115], v[20:23], v[64:67], 0
    s_waitcnt lgkmcnt(14)
    v_mfma_f32_16x16x32_bf16 v[96:99], v[24:27], v[64:67], 0
    s_waitcnt lgkmcnt(12)
    v_mfma_f32_16x16x32_bf16 v[116:119], v[28:31], v[64:67], 0
    s_waitcnt lgkmcnt(10)
    v_mfma_f32_16x16x32_bf16 v[100:103], v[32:35], v[64:67], 0
    s_waitcnt lgkmcnt(8)
    v_mfma_f32_16x16x32_bf16 v[120:123], v[36:39], v[64:67], 0
    s_waitcnt lgkmcnt(6)
    v_mfma_f32_16x16x32_bf16 v[104:107], v[40:43], v[64:67], 0
    s_waitcnt lgkmcnt(4)
    v_mfma_f32_16x16x32_bf16 v[124:127], v[44:47], v[64:67], 0
    s_waitcnt lgkmcnt(2)
    v_mfma_f32_16x16x32_bf16 v[108:111], v[48:51], v[64:67], 0
    s_waitcnt lgkmcnt(0)
    v_mfma_f32_16x16x32_bf16 v[128:131], v[52:55], v[64:67], 0
    s_lshl_b32 s42, s21, 7
    s_add_u32 s42, s42, 7340032
    s_mul_i32 s3, s41, 40960
    s_add_u32 s42, s42, s3
    v_cvt_pk_bf16_f32 v132, v92, v93
    v_cvt_pk_bf16_f32 v133, v94, v95
    v_cvt_pk_bf16_f32 v136, v96, v97
    v_cvt_pk_bf16_f32 v137, v98, v99
    v_xor_b32_dpp v134, v132, v13 quad_perm:[1,0,3,2] row_mask:0xf bank_mask:0xf
    v_xor_b32_dpp v135, v133, v13 quad_perm:[1,0,3,2] row_mask:0xf bank_mask:0xf
    v_and_b32 v233, 7, v1
    v_lshlrev_b32 v233, 2, v233
    v_mfma_f32_16x16x32_bf16 v[172:175], a[0:3], v[132:135], 0
    v_cvt_pk_bf16_f32 v140, v100, v101
    v_cvt_pk_bf16_f32 v141, v102, v103
    v_mfma_f32_16x16x32_bf16 v[176:179], a[20:23], v[132:135], 0
    v_xor_b32_dpp v138, v136, v13 quad_perm:[1,0,3,2] row_mask:0xf bank_mask:0xf
    v_xor_b32_dpp v139, v137, v13 quad_perm:[1,0,3,2] row_mask:0xf bank_mask:0xf
    s_nop 1
    v_mfma_f32_16x16x32_bf16 v[172:175], a[4:7], v[136:139], v[172:175]
    v_cvt_pk_bf16_f32 v144, v104, v105
    v_cvt_pk_bf16_f32 v145, v106, v107
    v_mfma_f32_16x16x32_bf16 v[176:179], a[24:27], v[136:139], v[176:179]
    v_xor_b32_dpp v142, v140, v13 quad_perm:[1,0,3,2] row_mask:0xf bank_mask:0xf
    v_xor_b32_dpp v143, v141, v13 quad_perm:[1,0,3,2] row_mask:0xf bank_mask:0xf
    s_nop 1
    v_mfma_f32_16x16x32_bf16 v[172:175], a[8:11], v[140:143], v[172:175]
    v_cvt_pk_bf16_f32 v148, v108, v109
    v_cvt_pk_bf16_f32 v149, v110, v111
    v_mfma_f32_16x16x32_bf16 v[176:179], a[28:31], v[140:143], v[176:179]
    v_xor_b32_dpp v146, v144, v13 quad_perm:[1,0,3,2] row_mask:0xf bank_mask:0xf
    v_xor_b32_dpp v147, v145, v13 quad_perm:[1,0,3,2] row_mask:0xf bank_mask:0xf
    s_nop 1
    v_mfma_f32_16x16x32_bf16 v[172:175], a[12:15], v[144:147], v[172:175]
    v_xor_b32_dpp v150, v148, v13 quad_perm:[1,0,3,2] row_mask:0xf bank_mask:0xf
    v_xor_b32_dpp v151, v149, v13 quad_perm:[1,0,3,2] row_mask:0xf bank_mask:0xf
    v_mfma_f32_16x16x32_bf16 v[176:179], a[32:35], v[144:147], v[176:179]
    v_cvt_pk_bf16_f32 v152, v112, v113
    ds_read_b128 a[100:103], v4 offset:25600
    v_mfma_f32_16x16x32_bf16 v[172:175], a[16:19], v[148:151], v[172:175]
    v_cvt_pk_bf16_f32 v153, v114, v115
    ds_read_b128 a[104:107], v4 offset:26624
    v_mfma_f32_16x16x32_bf16 v[176:179], a[36:39], v[148:151], v[176:179]
    v_cvt_pk_bf16_f32 v156, v116, v117
    ds_read_b128 a[108:111], v4 offset:27648
    v_mfma_f32_16x16x32_bf16 v[180:183], a[40:43], v[132:135], 0
    v_cvt_pk_bf16_f32 v157, v118, v119
    ds_read_b128 a[112:115], v4 offset:28672
    v_mfma_f32_16x16x32_bf16 v[184:187], a[60:63], v[132:135], 0
    v_xor_b32_dpp v154, v152, v13 quad_perm:[1,0,3,2] row_mask:0xf bank_mask:0xf
    ds_read_b128 a[116:119], v4 offset:29696
    v_mfma_f32_16x16x32_bf16 v[180:183], a[44:47], v[136:139], v[180:183]
    v_cvt_pk_bf16_f32 v172, v172, v173
    ds_read_b128 a[120:123], v4 offset:30720
    v_mfma_f32_16x16x32_bf16 v[184:187], a[64:67], v[136:139], v[184:187]
    v_cvt_pk_bf16_f32 v173, v174, v175
    ds_read_b128 a[124:127], v4 offset:31744
    v_mfma_f32_16x16x32_bf16 v[180:183], a[48:51], v[140:143], v[180:183]
    v_cvt_pk_bf16_f32 v174, v176, v177
    ds_read_b128 a[128:131], v4 offset:32768
    v_mfma_f32_16x16x32_bf16 v[184:187], a[68:71], v[140:143], v[184:187]
    v_cvt_pk_bf16_f32 v175, v178, v179
    ds_read_b128 a[132:135], v4 offset:33792
    v_mfma_f32_16x16x32_bf16 v[180:183], a[52:55], v[144:147], v[180:183]
    s_add_u32 s43, s42, 0
    buffer_store_dwordx4 v[172:175], v226, s[8:11], s43 offen sc1
    ds_read_b128 a[136:139], v4 offset:34816
    v_mfma_f32_16x16x32_bf16 v[184:187], a[72:75], v[144:147], v[184:187]
    v_xor_b32_dpp v155, v153, v13 quad_perm:[1,0,3,2] row_mask:0xf bank_mask:0xf
    ds_read_b128 a[140:143], v4 offset:35840
    v_mfma_f32_16x16x32_bf16 v[180:183], a[56:59], v[148:151], v[180:183]
    v_cvt_pk_bf16_f32 v160, v120, v121
    ds_read_b128 a[144:147], v4 offset:36864
    v_mfma_f32_16x16x32_bf16 v[184:187], a[76:79], v[148:151], v[184:187]
    v_cvt_pk_bf16_f32 v161, v122, v123
    ds_read_b128 a[148:151], v4 offset:37888
    v_mfma_f32_16x16x32_bf16 v[188:191], a[80:83], v[132:135], 0
    v_xor_b32_dpp v158, v156, v13 quad_perm:[1,0,3,2] row_mask:0xf bank_mask:0xf
    ds_read_b128 a[152:155], v4 offset:38912
    v_mfma_f32_16x16x32_bf16 v[188:191], a[84:87], v[136:139], v[188:191]
    v_xor_b32_dpp v159, v157, v13 quad_perm:[1,0,3,2] row_mask:0xf bank_mask:0xf
    ds_read_b128 a[156:159], v4 offset:39936
    v_mfma_f32_16x16x32_bf16 v[188:191], a[88:91], v[140:143], v[188:191]
    v_cvt_pk_bf16_f32 v180, v180, v181
    v_cvt_pk_bf16_f32 v181, v182, v183
    v_mfma_f32_16x16x32_bf16 v[188:191], a[92:95], v[144:147], v[188:191]
    v_cvt_pk_bf16_f32 v182, v184, v185
    v_cvt_pk_bf16_f32 v183, v186, v187
    v_mfma_f32_16x16x32_bf16 v[188:191], a[96:99], v[148:151], v[188:191]
    s_add_u32 s43, s42, 8192
    buffer_store_dwordx4 v[180:183], v227, s[8:11], s43 offen sc1
    v_cvt_pk_bf16_f32 v164, v124, v125
    v_cvt_pk_bf16_f32 v165, v126, v127
    v_xor_b32_dpp v162, v160, v13 quad_perm:[1,0,3,2] row_mask:0xf bank_mask:0xf
    v_xor_b32_dpp v163, v161, v13 quad_perm:[1,0,3,2] row_mask:0xf bank_mask:0xf
    v_cvt_pk_bf16_f32 v168, v128, v129
    v_cvt_pk_bf16_f32 v169, v130, v131
    v_xor_b32_dpp v166, v164, v13 quad_perm:[1,0,3,2] row_mask:0xf bank_mask:0xf
    v_xor_b32_dpp v167, v165, v13 quad_perm:[1,0,3,2] row_mask:0xf bank_mask:0xf
    v_xor_b32_dpp v170, v168, v13 quad_perm:[1,0,3,2] row_mask:0xf bank_mask:0xf
    v_xor_b32_dpp v171, v169, v13 quad_perm:[1,0,3,2] row_mask:0xf bank_mask:0xf
    s_waitcnt lgkmcnt(10)
    v_mfma_f32_16x16x32_bf16 v[192:195], a[100:103], v[152:155], 0
    s_bfe_u32 s60, s2, 0x20001
    s_lshl_b32 s60, s60, 2
    s_waitcnt lgkmcnt(5)
    v_mfma_f32_16x16x32_bf16 v[196:199], a[120:123], v[152:155], 0
    s_bfe_u32 s3, s2, 0x20003
    s_add_u32 s60, s60, s3
    v_mfma_f32_16x16x32_bf16 v[192:195], a[104:107], v[156:159], v[192:195]
    v_cvt_pk_bf16_f32 v188, v188, v189
    v_cvt_pk_bf16_f32 v189, v190, v191
    v_mfma_f32_16x16x32_bf16 v[196:199], a[124:127], v[156:159], v[196:199]
    s_add_u32 s43, s42, 16384
    buffer_store_dwordx2 v[188:189], v229, s[8:11], s43 offen sc1
    v_mfma_f32_16x16x32_bf16 v[192:195], a[108:111], v[160:163], v[192:195]
    s_bfe_u32 s3, s2, 0x10005
    s_lshl_b32 s50, s22, 1
    v_mfma_f32_16x16x32_bf16 v[196:199], a[128:131], v[160:163], v[196:199]
    s_add_u32 s50, s50, s3
    s_lshr_b32 s37, s50, 1
    v_mfma_f32_16x16x32_bf16 v[192:195], a[112:115], v[164:167], v[192:195]
    s_cmp_eq_u32 s37, 3
    s_cselect_b32 s37, 5, s37
    s_add_u32 s36, s37, 3
    s_lshl_b32 s3, s50, 2
    v_mfma_f32_16x16x32_bf16 v[196:199], a[132:135], v[164:167], v[196:199]
    s_lshr_b32 s61, 1985229328, s3
    s_lshr_b32 s38, 4275878552, s3
    v_mfma_f32_16x16x32_bf16 v[192:195], a[116:119], v[168:171], v[192:195]
    s_bitcmp1_b32 s2, 0
    s_cselect_b32 s37, s37, s36
    s_cselect_b32 s61, s38, s61
    s_cselect_b32 s3, 8, 0
    s_and_b32 s61, s61, 15
    s_and_b32 s36, s50, 1
    v_mfma_f32_16x16x32_bf16 v[196:199], a[136:139], v[168:171], v[196:199]
    s_or_b32 s50, s50, s3
    s_sub_u32 s3, 4, s37
    s_waitcnt lgkmcnt(0)
    v_mfma_f32_16x16x32_bf16 v[200:203], a[140:143], v[152:155], 0
    s_cmp_eq_u32 s36, 0
    s_cselect_b32 s38, s37, s3
    s_sub_u32 s3, 32, s60
    s_cmp_eq_u32 s60, 0
    s_cselect_b32 s3, 16, s3
    s_cmp_eq_u32 s36, 0
    s_cselect_b32 s39, s60, s3
    s_lshr_b32 s44, s50, 3
    v_mfma_f32_16x16x32_bf16 v[200:203], a[144:147], v[156:159], v[200:203]
    s_lshl_b32 s44, s44, 2
    s_and_b32 s3, s50, 3
    v_mfma_f32_16x16x32_bf16 v[200:203], a[148:151], v[160:163], v[200:203]
    v_cvt_pk_bf16_f32 v192, v192, v193
    v_cvt_pk_bf16_f32 v193, v194, v195
    v_mfma_f32_16x16x32_bf16 v[200:203], a[152:155], v[164:167], v[200:203]
    v_cvt_pk_bf16_f32 v194, v196, v197
    v_cvt_pk_bf16_f32 v195, v198, v199
    v_mfma_f32_16x16x32_bf16 v[200:203], a[156:159], v[168:171], v[200:203]
    s_add_u32 s43, s42, 163840
    buffer_store_dwordx4 v[192:195], v228, s[8:11], s43 offen sc1
    s_nop 5
    v_cvt_pk_bf16_f32 v200, v200, v201
    v_cvt_pk_bf16_f32 v201, v202, v203
    buffer_load_dword v225, v233, s[56:59], 0 offen sc1
    s_add_u32 s43, s42, 180224
    buffer_store_dwordx2 v[200:201], v229, s[8:11], s43 offen sc1
    s_or_b32 s44, s44, s3
    s_bfe_u32 s49, s50, 0x10002
    s_and_b32 s3, s60, 3
    s_lshl_b32 s3, s3, 1
    s_add_u32 s49, s49, s3
    s_lshl_b32 s35, s20, 9
    s_add_u32 s35, s35, s39
    s_mul_i32 s35, s35, 1280
    s_lshl_b32 s3, s38, 8
    s_add_u32 s35, s35, s3
    s_lshl_b32 s54, s20, 12
    s_add_u32 s54, s54, 147456
    s_mul_i32 s30, s61, 7
    s_mul_i32 s3, s61, 6
    s_add_u32 s3, s3, 12
    s_cmp_le_u32 s61, 11
    s_cselect_b32 s30, s30, s3
    s_cselect_b32 s47, 14, 12
    s_and_b32 s31, s30, 1
    s_lshl_b32 s32, s30, 5
    s_mul_i32 s3, s20, 110592
    s_add_u32 s32, s32, s3
    s_mul_i32 s55, s20, 7168
    s_movk_i32 s3, 3456
    s_mul_i32 s46, s44, 56
    s_mul_i32 s3, s20, 14
    s_add_u32 s46, s46, s3
    s_mul_i32 s46, s46, 5120
    s_add_u32 s46, s46, 4194304
    s_cmp_eq_u32 s20, 3
    s_cselect_b32 s47, 12, 14
    v_mul_u32_u24 v167, 40960, v2
    v_xor_b32 v8, v3, v2
    v_lshl_add_u32 v167, v8, 4, v167
    v_accvgpr_read_b32 v160, a240
    v_accvgpr_read_b32 v161, a241
    v_accvgpr_read_b32 v162, a242
    v_accvgpr_read_b32 v163, a243
    v_accvgpr_read_b32 v164, a244
    v_accvgpr_read_b32 v165, a245
    v_accvgpr_read_b32 v166, a246
    s_mov_b32 s53, 3
    s_mul_i32 s33, s53, 442368
    s_add_u32 s33, s33, s32
    s_mul_i32 s53, s53, 28672
    s_add_u32 s53, s53, s55
    s_add_u32 m0, s53, 0
    s_nop 0
    buffer_load_dwordx4 v160, s[24:27], s33 offen  lds
    s_add_u32 m0, s53, 1024
    s_nop 0
    buffer_load_dwordx4 v161, s[24:27], s33 offen  lds
    s_add_u32 m0, s53, 2048
    s_nop 0
    buffer_load_dwordx4 v162, s[24:27], s33 offen  lds
    s_mov_b32 s100, s33
    s_mov_b32 s41, 2147483648
    s_lshr_b32 s35, s2, 1
    s_add_u32 s35, s35, 32
    s_cmp_lt_u32 s2, 64
    s_cselect_b32 s35, s2, s35
    s_cmp_lt_u32 s37, 5
    s_cselect_b32 s35, 112, s35
    s_cmp_ge_u32 s35, 112
    s_cbranch_scc1 Lnotask17
    s_bfe_u32 s62, s35, 0x20001
    s_lshr_b32 s63, s35, 3
    s_and_b32 s35, s35, 1
    s_mov_b32 s0, 3414643728
    s_mov_b32 s1, 14246563
    s_mov_b32 s28, 2843099920
    s_mov_b32 s29, 12079871
    s_cmp_lt_u32 s62, 3
    s_cselect_b64 s[0:1], s[0:1], s[28:29]
    s_lshl_b32 s3, s63, 2
    s_lshr_b64 s[0:1], s[0:1], s3
    s_and_b32 s0, s0, 15
    s_cmp_eq_u32 s0, 15
    s_cbranch_scc1 Lnotask17
    s_mul_i32 s34, s62, 14
    s_add_u32 s0, s0, s34
    s_lshl_b32 s0, s0, 2
    s_add_u32 s0, s0, s20
    s_mul_i32 s33, s0, 10240
    s_lshl_b32 s3, s35, 7
    s_add_u32 s1, s33, s3
    s_add_u32 s1, s1, 1024
    s_lshl_b32 s3, s35, 9
    s_add_u32 s33, s33, s3
    s_lshl_b32 s35, s35, 2
    s_add_u32 s35, s35, s20
    s_mul_i32 s40, s35, 56
    s_add_u32 s40, s40, s34
    s_add_u32 s40, s40, s63
    s_mul_i32 s40, s40, 5120
    s_add_u32 s40, s40, 4194304
    s_lshl_b32 s41, s35, 2
    s_add_u32 s41, s41, s62
    s_add_u32 s41, s41, 160
    s_lshl_b32 s41, s41, 8
    s_mul_i32 s34, s20, 5120
    s_add_u32 s34, s34, 122880
    v_lshrrev_b32 v6, 3, v1
    v_mul_u32_u24 v6, 1280, v6
    v_and_b32 v8, 7, v1
    v_lshl_add_u32 v6, v8, 4, v6
    s_add_u32 m0, s34, 0
    s_nop 0
    buffer_load_dwordx4 v6, s[12:15], s33 offen offset:0  lds
    s_add_u32 m0, s34, 896
    s_nop 0
    buffer_load_dwordx4 v6, s[12:15], s33 offen offset:128  lds
    s_add_u32 m0, s34, 1792
    s_nop 0
    buffer_load_dwordx4 v6, s[12:15], s33 offen offset:256  lds
    s_add_u32 m0, s34, 2688
    s_nop 0
    buffer_load_dwordx4 v6, s[12:15], s33 offen offset:384  lds
    s_add_u32 m0, s34, 4096
    s_nop 0
    buffer_load_dwordx4 v6, s[12:15], s1 offen  lds
Lnotask17:
    s_mov_b32 s43, 2147483648
    s_mov_b32 s33, s100
    s_add_u32 m0, s53, 3072
    s_nop 0
    buffer_load_dwordx4 v163, s[24:27], s33 offen  lds
    s_add_u32 m0, s53, 4096
    s_nop 0
    buffer_load_dwordx4 v164, s[24:27], s33 offen  lds
    s_add_u32 m0, s53, 5120
    s_nop 0
    buffer_load_dwordx4 v165, s[24:27], s33 offen  lds
    s_bfe_u32 s3, s2, 0x40003
    v_lshl_add_u32 v12, v1, 4, s3
    v_lshlrev_b32 v12, 8, v12
    s_lshl_b32 s3, s44, 2
    s_add_u32 s3, s3, s20
    s_add_u32 s3, s3, 160
    s_lshl_b32 s3, s3, 8
    v_mov_b32 v11, s3
    s_cmp_ge_u32 s37, 5
    s_cbranch_scc0 Lopt18
    s_waitcnt vmcnt(11)
Lopt18:
    s_cmp_lt_u32 s37, 5
    s_cselect_b32 s3, 0, s41
    s_cmp_eq_u32 s3, 2147483648
    s_cbranch_scc0 Lopt19
    s_waitcnt vmcnt(6)
Lopt19:
    v_cmp_ne_u32 vcc, 1, v225
    s_cbranch_vccz Lok20
    s_mov_b64 exec, 0xff
    s_mov_b32 s63, 100000
Lpoll21:
    buffer_load_dword v225, v233, s[56:59], 0 offen sc1
    s_sub_u32 s63, s63, 1
    s_cbranch_scc1 Lpolld22
    s_waitcnt vmcnt(0)
    v_cmp_ne_u32 vcc, 1, v225
    s_cbranch_vccz Lpolld22
    s_sleep 2
    s_branch Lpoll21
Lpolld22:
    s_waitcnt vmcnt(0)
    s_mov_b64 exec, -1
Lok20:
    s_barrier
    s_cmp_eq_u32 s20, 0
    s_cbranch_scc0 Lopt23
    s_mov_b64 exec, 0xff
    buffer_atomic_add v5, v12, s[8:11], 0 offen sc1
    s_mov_b64 exec, -1
Lopt23:
LA_end:
    s_cmp_ge_u32 s37, 5
    s_cbranch_scc1 LB_idle
    v_lshlrev_b32 v7, 2, v2
    v_xor_b32 v7, v7, v3
    v_lshlrev_b32 v7, 4, v7
    v_lshl_add_u32 v7, v3, 8, v7
    s_lshl_b32 s3, s20, 12
    s_add_u32 s3, s3, 147456
    v_add_u32 v7, s3, v7
    v_mov_b32 v26, v7
    v_lshl_add_u32 v6, s20, 4, v3
    v_lshl_add_u32 v6, v6, 5, s39
    v_cvt_f32_u32 v6, v6
    v_mul_f32 v6, 0x3a000000, v6
    v_and_b32 v7, 1, v2
    v_lshlrev_b32 v20, 31, v7
    v_lshrrev_b32 v8, 16, v20
    v_or_b32 v20, v20, v8
    v_lshrrev_b32 v8, 5, v1
    v_lshlrev_b32 v22, 3, v3
    v_lshl_add_u32 v22, v8, 2, v22
    v_lshlrev_b32 v8, 3, v8
    v_cvt_f32_u32 v124, v8
    v_bfe_u32 v9, v1, 2, 2
    v_add_u32 v8, v8, v9
    v_lshlrev_b32 v18, 5, v7
    v_add_u32 v18, 143360, v18
    v_lshl_add_u32 v16, v8, 7, v18
    v_lshl_add_u32 v18, v8, 6, v18
    v_lshrrev_b32 v9, 1, v9
    v_xor_b32 v8, 1, v9
    v_lshl_add_u32 v17, v8, 6, v16
    v_lshl_add_u32 v16, v9, 6, v16
    v_and_b32 v8, 3, v1
    v_xor_b32 v9, 3, v8
    v_lshl_add_u32 v16, v8, 3, v16
    v_lshl_add_u32 v17, v9, 3, v17
    v_lshl_add_u32 v19, v9, 3, v18
    v_lshl_add_u32 v18, v8, 3, v18
    v_cvt_f32_u32 v7, v7
    v_sub_f32 v7, 1.0, v7
    v_mul_f32 v7, 0x3e800000, v7
    v_fma_f32 v7, v6, v124, v7
    s_cmp_le_u32 s38, 2
    s_cselect_b32 s3, 0, -1
    s_cselect_b64 s[40:41], -1, 0
    v_and_b32 v27, s3, v20
    v_cndmask_b32 v19, v19, v18, s[40:41]
    v_fmamk_f32 v124, v6, 0x0, v7
    v_fmamk_f32 v125, v6, 0x3f800000, v7
    v_fmamk_f32 v126, v6, 0x40000000, v7
    v_fmamk_f32 v127, v6, 0x40400000, v7
    v_fmamk_f32 v128, v6, 0x40800000, v7
    v_fmamk_f32 v129, v6, 0x40a00000, v7
    s_add_u32 m0, s53, 6144
    s_nop 0
    buffer_load_dwordx4 v166, s[24:27], s33 offen  lds
    v_fmamk_f32 v130, v6, 0x40c00000, v7
    v_fmamk_f32 v131, v6, 0x40e00000, v7
    v_sin_f32 v124, v124
    v_sin_f32 v125, v125
    v_sin_f32 v126, v126
    v_sin_f32 v127, v127
    s_mov_b32 s53, 2
    s_mul_i32 s33, s53, 442368
    s_add_u32 s33, s33, s32
    s_mul_i32 s53, s53, 28672
    s_add_u32 s53, s53, s55
    s_add_u32 m0, s53, 0
    s_nop 0
    buffer_load_dwordx4 v160, s[24:27], s33 offen  lds
    v_sin_f32 v128, v128
    v_sin_f32 v129, v129
    v_sin_f32 v130, v130
    v_sin_f32 v131, v131
    v_cvt_pk_bf16_f32 v76, v124, v125
    v_cvt_pk_bf16_f32 v77, v126, v127
    s_add_u32 m0, s53, 1024
    s_nop 0
    buffer_load_dwordx4 v161, s[24:27], s33 offen  lds
    v_cvt_pk_bf16_f32 v78, v128, v129
    v_cvt_pk_bf16_f32 v79, v130, v131
    v_fmamk_f32 v124, v6, 0x41800000, v7
    v_fmamk_f32 v125, v6, 0x41880000, v7
    v_fmamk_f32 v126, v6, 0x41900000, v7
    v_fmamk_f32 v127, v6, 0x41980000, v7
    s_add_u32 m0, s53, 2048
    s_nop 0
    buffer_load_dwordx4 v162, s[24:27], s33 offen  lds
    v_fmamk_f32 v128, v6, 0x41a00000, v7
    v_fmamk_f32 v129, v6, 0x41a80000, v7
    v_fmamk_f32 v130, v6, 0x41b00000, v7
    v_fmamk_f32 v131, v6, 0x41b80000, v7
    v_sin_f32 v124, v124
    v_sin_f32 v125, v125
    s_add_u32 m0, s53, 3072
    s_nop 0
    buffer_load_dwordx4 v163, s[24:27], s33 offen  lds
    v_sin_f32 v126, v126
    v_sin_f32 v127, v127
    v_sin_f32 v128, v128
    v_sin_f32 v129, v129
    v_sin_f32 v130, v130
    v_sin_f32 v131, v131
    s_add_u32 m0, s53, 4096
    s_nop 0
    buffer_load_dwordx4 v164, s[24:27], s33 offen  lds
    v_cvt_pk_bf16_f32 v80, v124, v125
    v_cvt_pk_bf16_f32 v81, v126, v127
    v_cvt_pk_bf16_f32 v82, v128, v129
    v_cvt_pk_bf16_f32 v83, v130, v131
    v_fmamk_f32 v124, v6, 0x42000000, v7
    v_fmamk_f32 v125, v6, 0x42040000, v7
    s_add_u32 m0, s53, 5120
    s_nop 0
    buffer_load_dwordx4 v165, s[24:27], s33 offen  lds
    v_fmamk_f32 v126, v6, 0x42080000, v7
    v_fmamk_f32 v127, v6, 0x420c0000, v7
    v_fmamk_f32 v128, v6, 0x42100000, v7
    v_fmamk_f32 v129, v6, 0x42140000, v7
    v_fmamk_f32 v130, v6, 0x42180000, v7
    v_fmamk_f32 v131, v6, 0x421c0000, v7
    s_add_u32 m0, s53, 6144
    s_nop 0
    buffer_load_dwordx4 v166, s[24:27], s33 offen  lds
    v_sin_f32 v124, v124
    v_sin_f32 v125, v125
    v_sin_f32 v126, v126
    v_sin_f32 v127, v127
    v_sin_f32 v128, v128
    v_sin_f32 v129, v129
    s_mov_b32 s53, 0
    s_mul_i32 s33, s53, 442368
    s_add_u32 s33, s33, s32
    s_mul_i32 s53, s53, 28672
    s_add_u32 s53, s53, s55
    s_add_u32 m0, s53, 0
    s_nop 0
    buffer_load_dwordx4 v160, s[24:27], s33 offen  lds
    v_sin_f32 v130, v130
    v_sin_f32 v131, v131
    v_cvt_pk_bf16_f32 v84, v124, v125
    v_cvt_pk_bf16_f32 v85, v126, v127
    v_cvt_pk_bf16_f32 v86, v128, v129
    v_cvt_pk_bf16_f32 v87, v130, v131
    s_add_u32 m0, s53, 1024
    s_nop 0
    buffer_load_dwordx4 v161, s[24:27], s33 offen  lds
    v_fmamk_f32 v124, v6, 0x42400000, v7
    v_fmamk_f32 v125, v6, 0x42440000, v7
    v_fmamk_f32 v126, v6, 0x42480000, v7
    v_fmamk_f32 v127, v6, 0x424c0000, v7
    v_fmamk_f32 v128, v6, 0x42500000, v7
    v_fmamk_f32 v129, v6, 0x42540000, v7
    s_add_u32 m0, s53, 2048
    s_nop 0
    buffer_load_dwordx4 v162, s[24:27], s33 offen  lds
    v_fmamk_f32 v130, v6, 0x42580000, v7
    v_fmamk_f32 v131, v6, 0x425c0000, v7
    v_sin_f32 v124, v124
    v_sin_f32 v125, v125
    v_sin_f32 v126, v126
    v_sin_f32 v127, v127
    s_add_u32 m0, s53, 3072
    s_nop 0
    buffer_load_dwordx4 v163, s[24:27], s33 offen  lds
    v_sin_f32 v128, v128
    v_sin_f32 v129, v129
    v_sin_f32 v130, v130
    v_sin_f32 v131, v131
    v_cvt_pk_bf16_f32 v88, v124, v125
    v_cvt_pk_bf16_f32 v89, v126, v127
    s_add_u32 m0, s53, 4096
    s_nop 0
    buffer_load_dwordx4 v164, s[24:27], s33 offen  lds
    v_cvt_pk_bf16_f32 v90, v128, v129
    v_cvt_pk_bf16_f32 v91, v130, v131
    v_xor_b32 v92, v20, v76
    v_xor_b32 v108, v27, v76
    v_xor_b32 v93, v20, v77
    v_xor_b32 v109, v27, v77
    s_add_u32 m0, s53, 5120
    s_nop 0
    buffer_load_dwordx4 v165, s[24:27], s33 offen  lds
    v_xor_b32 v94, v20, v78
    v_xor_b32 v110, v27, v78
    v_xor_b32 v95, v20, v79
    v_xor_b32 v111, v27, v79
    v_xor_b32 v96, v20, v80
    v_xor_b32 v112, v27, v80
    s_add_u32 m0, s53, 6144
    s_nop 0
    buffer_load_dwordx4 v166, s[24:27], s33 offen  lds
    v_xor_b32 v97, v20, v81
    v_xor_b32 v113, v27, v81
    v_xor_b32 v98, v20, v82
    v_xor_b32 v114, v27, v82
    v_xor_b32 v99, v20, v83
    v_xor_b32 v115, v27, v83
    s_mov_b32 s53, 1
    s_mul_i32 s33, s53, 442368
    s_add_u32 s33, s33, s32
    s_mul_i32 s53, s53, 28672
    s_add_u32 s53, s53, s55
    s_add_u32 m0, s53, 0
    s_nop 0
    buffer_load_dwordx4 v160, s[24:27], s33 offen  lds
    v_xor_b32 v100, v20, v84
    v_xor_b32 v116, v27, v84
    v_xor_b32 v101, v20, v85
    v_xor_b32 v117, v27, v85
    v_xor_b32 v102, v20, v86
    v_xor_b32 v118, v27, v86
    s_add_u32 m0, s53, 1024
    s_nop 0
    buffer_load_dwordx4 v161, s[24:27], s33 offen  lds
    v_xor_b32 v103, v20, v87
    v_xor_b32 v119, v27, v87
    v_xor_b32 v104, v20, v88
    v_xor_b32 v120, v27, v88
    v_xor_b32 v105, v20, v89
    v_xor_b32 v121, v27, v89
    s_add_u32 m0, s53, 2048
    s_nop 0
    buffer_load_dwordx4 v162, s[24:27], s33 offen  lds
    v_xor_b32 v106, v20, v90
    v_xor_b32 v122, v27, v90
    v_xor_b32 v107, v20, v91
    v_xor_b32 v123, v27, v91
    s_waitcnt vmcnt(21)
    ds_read_b128 v[28:31], v26
    v_xor_b32 v26, 16, v26
    ds_read_b128 v[32:35], v26
    v_xor_b32 v26, 48, v26
    ds_read_b128 v[36:39], v26
    v_xor_b32 v26, 16, v26
    ds_read_b128 v[40:43], v26
    s_waitcnt lgkmcnt(0)
    v_lshlrev_b32 v44, 16, v28
    v_and_b32 v48, 0xffff0000, v28
    s_add_u32 m0, s53, 3072
    s_nop 0
    buffer_load_dwordx4 v163, s[24:27], s33 offen  lds
    v_lshlrev_b32 v52, 16, v29
    v_and_b32 v56, 0xffff0000, v29
    v_lshlrev_b32 v60, 16, v30
    v_and_b32 v67, 0xffff0000, v30
    v_lshlrev_b32 v71, 16, v31
    v_and_b32 v75, 0xffff0000, v31
    v_lshlrev_b32 v45, 16, v32
    v_and_b32 v49, 0xffff0000, v32
    v_lshlrev_b32 v53, 16, v33
    v_and_b32 v57, 0xffff0000, v33
    v_lshlrev_b32 v61, 16, v34
    v_and_b32 v66, 0xffff0000, v34
    v_lshlrev_b32 v70, 16, v35
    v_and_b32 v74, 0xffff0000, v35
    v_lshlrev_b32 v46, 16, v36
    v_and_b32 v50, 0xffff0000, v36
    v_lshlrev_b32 v54, 16, v37
    v_and_b32 v58, 0xffff0000, v37
    v_lshlrev_b32 v62, 16, v38
    v_and_b32 v65, 0xffff0000, v38
    v_lshlrev_b32 v69, 16, v39
    v_and_b32 v73, 0xffff0000, v39
    v_lshlrev_b32 v47, 16, v40
    v_and_b32 v51, 0xffff0000, v40
    v_lshlrev_b32 v55, 16, v41
    v_and_b32 v59, 0xffff0000, v41
    v_lshlrev_b32 v63, 16, v42
    v_and_b32 v64, 0xffff0000, v42
    v_lshlrev_b32 v68, 16, v43
    v_and_b32 v72, 0xffff0000, v43
    s_lshl_b32 s40, s37, 13
    s_lshl_b32 s3, s36, 6
    s_add_u32 s40, s40, s3
    s_xor_b32 s41, s40, 64
    s_sub_u32 s42, 4, s37
    s_lshl_b32 s42, s42, 13
    s_add_u32 s42, s42, s3
    s_xor_b32 s43, s3, 64
    s_cmp_eq_u32 s60, 0
    s_cselect_b32 s41, s42, s41
    s_cselect_b32 s42, s3, s43
    s_sub_u32 s43, 4, s38
    s_cmp_le_u32 s38, 2
    s_cselect_b32 s42, s3, s42
    s_cselect_b32 s43, s38, s43
    s_lshl_b32 s43, s43, 13
    s_add_u32 s42, s42, s43
    v_lshrrev_b32 v6, 3, v0
    v_and_b32 v7, 3, v0
    v_lshlrev_b32 v7, 4, v7
    v_lshl_add_u32 v23, v6, 7, v7
    v_lshrrev_b32 v8, 2, v0
    v_lshl_add_u32 v24, v8, 7, v7
    v_lshrrev_b32 v6, 1, v6
    v_xor_b32 v6, v6, v8
    v_and_b32 v6, 1, v6
    v_cmp_eq_u32 vcc, 0, v6
    v_mov_b32 v7, s41
    v_mov_b32 v8, s40
    v_cndmask_b32 v7, v7, v8, vcc
    v_add_u32 v23, v23, v7
    v_add_u32 v25, s42, v24
    v_add_u32 v24, s40, v24
    s_mul_i32 s40, s60, 204800
    s_add_u32 s40, s40, 7340032
    s_add_u32 s41, s52, 143360
    v_lshlrev_b32 v20, 4, v0
    v_add_u32 v20, 143360, v20
    s_lshl_b32 s3, s36, 2
    s_lshl_b32 s42, s60, 3
    s_add_u32 s42, s42, s3
    s_add_u32 s42, s42, s20
    s_lshr_b32 s45, s42, 1
    s_add_u32 s45, s45, 192
    s_lshl_b32 s45, s45, 8
    s_lshl_b32 s43, s42, 3
    s_add_u32 s43, s43, s38
    s_lshl_b32 s43, s43, 7
    s_add_u32 s43, s43, 14680064
    s_mul_i32 s42, s42, 20480
    s_lshl_b32 s3, s38, 12
    s_add_u32 s42, s42, s3
    s_add_u32 s42, s42, 11534336
    v_lshlrev_b32 v21, 4, v3
    v_lshl_add_u32 v21, v2, 10, v21
    s_and_b32 s3, s2, 7
    s_lshl_b32 s3, s3, 4
    v_add_u32 v26, s3, v1
    v_lshlrev_b32 v26, 8, v26
    s_cmp_le_u32 s38, 2
    s_cbranch_scc1 Lsw24
    v_swap_b32 v60, v63
    v_swap_b32 v61, v62
Lsw24:
    v_lshrrev_b32 v6, 5, v1
    v_bfe_u32 v7, v1, 2, 3
    v_lshl_add_u32 v6, v6, 4, v7
    v_mul_u32_u24 v6, 224, v6
    v_and_b32 v7, 3, v1
    v_lshl_add_u32 v6, v7, 3, v6
    s_lshl_b32 s3, s31, 5
    v_add_u32 v168, s3, v6
    v_add_u32 v169, 57344, v168
    v_add_u32 v170, 114688, v168
    s_cmp_eq_u32 s31, 0
    s_cselect_b32 s3, 192, 0
    v_add_u32 v171, s3, v6
    v_add_u32 v172, 57344, v171
    v_add_u32 v173, 114688, v171
    s_lshl_b32 s3, s20, 6
    s_cmp_eq_u32 s20, 3
    s_cselect_b64 vcc, -1, 0
    s_cselect_b32 s0, 2147483648, 0
    v_or_b32 v10, s0, v4
    v_add_u32 v156, s3, v168
    v_cndmask_b32 v156, v156, v171, vcc
    v_add_u32 v157, s3, v169
    v_cndmask_b32 v157, v157, v172, vcc
    v_add_u32 v158, s3, v170
    v_cndmask_b32 v158, v158, v173, vcc
    v_lshlrev_b32 v167, 3, v3
    v_lshl_add_u32 v167, v2, 7, v167
    v_cmp_le_u32 vcc, 16, v1
    s_nop 1
    v_cndmask_b32 v6, 0, v5, vcc
    v_lshl_or_b32 v13, v6, 31, v167
    v_lshrrev_b32 v14, 1, v4
    v_or_b32 v14, s0, v14
    s_lshl_b32 s0, s60, 3
    s_lshl_b32 s3, s20, 1
    s_add_u32 s0, s0, s3
    s_lshl_b32 s23, s0, 10
    s_add_u32 s23, s23, 14680064
    s_mul_i32 s21, s0, 20480
    s_add_u32 s21, s21, 11534336
    s_add_u32 s22, s21, 20480
    s_lshr_b32 s3, s0, 1
    s_add_u32 s3, s3, 192
    s_lshl_b32 s3, s3, 8
    v_mov_b32 v174, s3
    s_lshr_b32 s1, s61, 2
    s_cmp_lt_u32 s1, 3
    s_cselect_b32 s3, 0, 2147483648
    v_lshrrev_b32 v175, 1, v4
    v_or_b32 v175, s3, v175
    s_and_b32 s48, s0, 0xfc
    s_add_u32 s48, s48, s1
    s_lshl_b32 s48, s48, 1
    s_add_u32 s48, s48, 256
    s_lshl_b32 s48, s48, 8
    s_mul_i32 s1, s1, 14
    s_mul_i32 s0, s0, 56
    s_add_u32 s0, s0, s1
    s_lshl_b32 s0, s0, 10
    s_add_u32 s0, s0, 16777216
    s_and_b32 s1, s61, 3
    s_lshl_b32 s12, s1, 11
    s_add_u32 s12, s12, s0
    s_add_u32 s13, s12, 1024
    s_add_u32 s14, s1, 10
    s_lshl_b32 s14, s14, 10
    s_add_u32 s14, s14, s0
    s_lshr_b32 s15, s1, 1
    s_add_u32 s15, s15, 8
    s_lshl_b32 s15, s15, 10
    s_add_u32 s15, s15, s0
    s_lshl_b32 s3, s31, 9
    s_add_u32 s15, s15, s3
    s_cmp_lg_u32 s20, 0
    s_cbranch_scc1 LB_nopoll
    s_mov_b64 exec, 0xffff
    s_mov_b32 s63, 100000
Lpoll25:
    buffer_load_dword v6, v26, s[8:11], 0 offen sc1
    s_sub_u32 s63, s63, 1
    s_cbranch_scc1 Lpolld26
    s_waitcnt vmcnt(0)
    v_cmp_ne_u32 vcc, 16, v6
    s_cbranch_vccz Lpolld26
    s_sleep 2
    s_branch Lpoll25
Lpolld26:
    s_waitcnt vmcnt(0)
    s_mov_b64 exec, -1
LB_nopoll:
    s_barrier
    s_add_u32 s3, s40, 0
    s_add_u32 m0, s41, 0
    s_nop 0
    buffer_load_dwordx4 v24, s[8:11], s3 offen sc1 lds
    s_add_u32 s3, s40, 40960
    s_add_u32 m0, s41, 4096
    s_nop 0
    buffer_load_dwordx4 v23, s[8:11], s3 offen sc1 lds
    s_add_u32 s3, s40, 45056
    s_add_u32 m0, s41, 8192
    s_nop 0
    buffer_load_dwordx4 v23, s[8:11], s3 offen sc1 lds
    s_add_u32 s3, s40, 81920
    s_add_u32 m0, s41, 12288
    s_nop 0
    buffer_load_dwordx4 v23, s[8:11], s3 offen sc1 lds
    s_add_u32 s3, s40, 86016
    s_add_u32 m0, s41, 16384
    s_nop 0
    buffer_load_dwordx4 v23, s[8:11], s3 offen sc1 lds
    s_add_u32 s3, s40, 122880
    buffer_load_dwordx4 v[28:31], v23, s[8:11], s3 offen sc1
    s_add_u32 s3, s40, 126976
    buffer_load_dwordx4 v[32:35], v23, s[8:11], s3 offen sc1
    s_add_u32 s3, s40, 163840
    buffer_load_dwordx4 v[36:39], v25, s[8:11], s3 offen sc1
    s_add_u32 m0, s53, 4096
    s_nop 0
    buffer_load_dwordx4 v164, s[24:27], s33 offen  lds
    s_add_u32 m0, s53, 5120
    s_nop 0
    buffer_load_dwordx4 v165, s[24:27], s33 offen  lds
    s_add_u32 m0, s53, 6144
    s_nop 0
    buffer_load_dwordx4 v166, s[24:27], s33 offen  lds
    s_mov_b32 s53, 4
    s_mul_i32 s33, s53, 442368
    s_add_u32 s33, s33, s32
    s_mul_i32 s53, s53, 28672
    s_add_u32 s53, s53, s55
    s_add_u32 m0, s53, 0
    s_nop 0
    buffer_load_dwordx4 v160, s[24:27], s33 offen  lds
    s_add_u32 m0, s53, 1024
    s_nop 0
    buffer_load_dwordx4 v161, s[24:27], s33 offen  lds
    s_waitcnt vmcnt(8)
    s_barrier
    ds_read_b64_tr_b16 v[124:125], v18 offset:0
    ds_read_b64_tr_b16 v[126:127], v18 offset:256
    ds_read_b64_tr_b16 v[128:129], v18 offset:1024
    ds_read_b64_tr_b16 v[130:131], v18 offset:1280
    ds_read_b64_tr_b16 v[132:133], v18 offset:2048
    ds_read_b64_tr_b16 v[134:135], v18 offset:2304
    ds_read_b64_tr_b16 v[136:137], v18 offset:3072
    ds_read_b64_tr_b16 v[138:139], v18 offset:3328
    ds_read_b64_tr_b16 v[140:141], v16 offset:4096
    ds_read_b64_tr_b16 v[142:143], v16 offset:4608
    ds_read_b64_tr_b16 v[144:145], v16 offset:6144
    ds_read_b64_tr_b16 v[146:147], v16 offset:6656
    ds_read_b64_tr_b16 v[148:149], v16 offset:8192
    ds_read_b64_tr_b16 v[150:151], v16 offset:8704
    s_waitcnt lgkmcnt(12)
    v_mfma_f32_16x16x32_bf16 v[44:47], v[124:127], v[76:79], v[44:47]
    ds_read_b64_tr_b16 v[152:153], v16 offset:10240
    ds_read_b64_tr_b16 v[154:155], v16 offset:10752
    s_waitcnt lgkmcnt(12)
    v_mfma_f32_16x16x32_bf16 v[44:47], v[128:131], v[80:83], v[44:47]
    ds_read_b64_tr_b16 v[124:125], v17 offset:4096
    ds_read_b64_tr_b16 v[126:127], v17 offset:4608
    s_add_u32 m0, s53, 2048
    s_nop 0
    buffer_load_dwordx4 v162, s[24:27], s33 offen  lds
    s_waitcnt lgkmcnt(12)
    v_mfma_f32_16x16x32_bf16 v[44:47], v[132:135], v[84:87], v[44:47]
    ds_read_b64_tr_b16 v[128:129], v17 offset:6144
    ds_read_b64_tr_b16 v[130:131], v17 offset:6656
    s_waitcnt lgkmcnt(12)
    v_mfma_f32_16x16x32_bf16 v[44:47], v[136:139], v[88:91], v[44:47]
    ds_read_b64_tr_b16 v[132:133], v17 offset:8192
    ds_read_b64_tr_b16 v[134:135], v17 offset:8704
    s_waitcnt lgkmcnt(12)
    v_mfma_f32_16x16x32_bf16 v[48:51], v[140:143], v[76:79], v[48:51]
    ds_read_b64_tr_b16 v[136:137], v17 offset:10240
    ds_read_b64_tr_b16 v[138:139], v17 offset:10752
    s_add_u32 m0, s53, 3072
    s_nop 0
    buffer_load_dwordx4 v163, s[24:27], s33 offen  lds
    s_waitcnt lgkmcnt(12)
    v_mfma_f32_16x16x32_bf16 v[48:51], v[144:147], v[80:83], v[48:51]
    ds_read_b64_tr_b16 v[140:141], v16 offset:12288
    ds_read_b64_tr_b16 v[142:143], v16 offset:12800
    s_waitcnt lgkmcnt(12)
    v_mfma_f32_16x16x32_bf16 v[48:51], v[148:151], v[84:87], v[48:51]
    ds_read_b64_tr_b16 v[144:145], v16 offset:14336
    ds_read_b64_tr_b16 v[146:147], v16 offset:14848
    s_waitcnt lgkmcnt(12)
    v_mfma_f32_16x16x32_bf16 v[48:51], v[152:155], v[88:91], v[48:51]
    ds_read_b64_tr_b16 v[148:149], v16 offset:16384
    ds_read_b64_tr_b16 v[150:151], v16 offset:16896
    s_add_u32 m0, s53, 4096
    s_nop 0
    buffer_load_dwordx4 v164, s[24:27], s33 offen  lds
    s_waitcnt lgkmcnt(12)
    v_mfma_f32_16x16x32_bf16 v[72:75], v[124:127], v[92:95], v[72:75]
    ds_read_b64_tr_b16 v[152:153], v16 offset:18432
    ds_read_b64_tr_b16 v[154:155], v16 offset:18944
    s_waitcnt lgkmcnt(12)
    v_mfma_f32_16x16x32_bf16 v[72:75], v[128:131], v[96:99], v[72:75]
    ds_read_b64_tr_b16 v[124:125], v17 offset:12288
    ds_read_b64_tr_b16 v[126:127], v17 offset:12800
    s_waitcnt lgkmcnt(12)
    v_mfma_f32_16x16x32_bf16 v[72:75], v[132:135], v[100:103], v[72:75]
    ds_read_b64_tr_b16 v[128:129], v17 offset:14336
    ds_read_b64_tr_b16 v[130:131], v17 offset:14848
    s_add_u32 m0, s53, 5120
    s_nop 0
    buffer_load_dwordx4 v165, s[24:27], s33 offen  lds
    s_waitcnt lgkmcnt(12)
    v_mfma_f32_16x16x32_bf16 v[72:75], v[136:139], v[104:107], v[72:75]
    ds_read_b64_tr_b16 v[132:133], v17 offset:16384
    ds_read_b64_tr_b16 v[134:135], v17 offset:16896
    s_waitcnt vmcnt(9)
    s_barrier
    ds_write_b128 v20, v[28:31] offset:4096
    ds_write_b128 v20, v[32:35] offset:8192
    ds_write_b128 v20, v[36:39] offset:0
    s_waitcnt lgkmcnt(15)
    v_mfma_f32_16x16x32_bf16 v[52:55], v[140:143], v[76:79], v[52:55]
    ds_read_b64_tr_b16 v[136:137], v17 offset:18432
    ds_read_b64_tr_b16 v[138:139], v17 offset:18944
    s_waitcnt lgkmcnt(15)
    v_mfma_f32_16x16x32_bf16 v[52:55], v[144:147], v[80:83], v[52:55]
    s_add_u32 m0, s53, 6144
    s_nop 0
    buffer_load_dwordx4 v166, s[24:27], s33 offen  lds
    s_waitcnt lgkmcnt(13)
    v_mfma_f32_16x16x32_bf16 v[52:55], v[148:151], v[84:87], v[52:55]
    s_waitcnt lgkmcnt(2)
    s_barrier
    v_mfma_f32_16x16x32_bf16 v[52:55], v[152:155], v[88:91], v[52:55]
    ds_read_b64_tr_b16 v[140:141], v16 offset:4096
    ds_read_b64_tr_b16 v[142:143], v16 offset:4608
    ds_read_b64_tr_b16 v[144:145], v16 offset:6144
    ds_read_b64_tr_b16 v[146:147], v16 offset:6656
    ds_read_b64_tr_b16 v[148:149], v16 offset:8192
    ds_read_b64_tr_b16 v[150:151], v16 offset:8704
    v_mfma_f32_16x16x32_bf16 v[68:71], v[124:127], v[92:95], v[68:71]
    ds_read_b64_tr_b16 v[152:153], v16 offset:10240
    ds_read_b64_tr_b16 v[154:155], v16 offset:10752
    v_mfma_f32_16x16x32_bf16 v[68:71], v[128:131], v[96:99], v[68:71]
    ds_read_b64_tr_b16 v[124:125], v17 offset:4096
    ds_read_b64_tr_b16 v[126:127], v17 offset:4608
    v_mfma_f32_16x16x32_bf16 v[68:71], v[132:135], v[100:103], v[68:71]
    ds_read_b64_tr_b16 v[128:129], v17 offset:6144
    ds_read_b64_tr_b16 v[130:131], v17 offset:6656
    s_waitcnt lgkmcnt(12)
    v_mfma_f32_16x16x32_bf16 v[68:71], v[136:139], v[104:107], v[68:71]
    ds_read_b64_tr_b16 v[132:133], v17 offset:8192
    ds_read_b64_tr_b16 v[134:135], v17 offset:8704
    s_waitcnt lgkmcnt(12)
    v_mfma_f32_16x16x32_bf16 v[56:59], v[140:143], v[76:79], v[56:59]
    ds_read_b64_tr_b16 v[136:137], v17 offset:10240
    ds_read_b64_tr_b16 v[138:139], v17 offset:10752
    buffer_load_dword v15, v11, s[8:11], 0 offen sc1
    s_waitcnt lgkmcnt(12)
    v_mfma_f32_16x16x32_bf16 v[56:59], v[144:147], v[80:83], v[56:59]
    ds_read_b64_tr_b16 v[140:141], v19 offset:0
    ds_read_b64_tr_b16 v[142:143], v19 offset:256
    s_waitcnt lgkmcnt(12)
    v_mfma_f32_16x16x32_bf16 v[56:59], v[148:151], v[84:87], v[56:59]
    ds_read_b64_tr_b16 v[144:145], v19 offset:1024
    ds_read_b64_tr_b16 v[146:147], v19 offset:1280
    s_waitcnt lgkmcnt(12)
    v_mfma_f32_16x16x32_bf16 v[56:59], v[152:155], v[88:91], v[56:59]
    ds_read_b64_tr_b16 v[148:149], v19 offset:2048
    ds_read_b64_tr_b16 v[150:151], v19 offset:2304
    s_waitcnt lgkmcnt(12)
    v_mfma_f32_16x16x32_bf16 v[64:67], v[124:127], v[92:95], v[64:67]
    ds_read_b64_tr_b16 v[152:153], v19 offset:3072
    ds_read_b64_tr_b16 v[154:155], v19 offset:3328
    s_waitcnt lgkmcnt(12)
    v_mfma_f32_16x16x32_bf16 v[64:67], v[128:131], v[96:99], v[64:67]
    s_waitcnt lgkmcnt(10)
    v_mfma_f32_16x16x32_bf16 v[64:67], v[132:135], v[100:103], v[64:67]
    s_waitcnt lgkmcnt(8)
    v_mfma_f32_16x16x32_bf16 v[64:67], v[136:139], v[104:107], v[64:67]
    s_waitcnt lgkmcnt(6)
    v_mfma_f32_16x16x32_bf16 v[60:63], v[140:143], v[108:111], v[60:63]
    s_waitcnt lgkmcnt(4)
    v_mfma_f32_16x16x32_bf16 v[60:63], v[144:147], v[112:115], v[60:63]
    s_waitcnt lgkmcnt(2)
    v_mfma_f32_16x16x32_bf16 v[60:63], v[148:151], v[116:119], v[60:63]
    s_waitcnt lgkmcnt(0)
    v_mfma_f32_16x16x32_bf16 v[60:63], v[152:155], v[120:123], v[60:63]
    v_mov_b32 v40, 0
    v_mov_b32 v41, 0
    v_mov_b32 v42, 0
    v_mov_b32 v43, 0
    s_nop 3
    s_cmp_le_u32 s38, 2
    s_cbranch_scc1 Lsw27
    v_swap_b32 v60, v63
    v_swap_b32 v61, v62
Lsw27:
    v_cvt_pk_bf16_f32 v124, v44, v48
    v_cvt_pk_bf16_f32 v125, v52, v56
    v_cvt_pk_bf16_f32 v126, v60, v67
    v_cvt_pk_bf16_f32 v127, v71, v75
    buffer_store_dwordx4 v[124:127], v21, s[8:11], s42 offen offset:0 sc1
    v_dot2_f32_bf16 v40, v124, s51, v40
    v_dot2_f32_bf16 v41, v124, v124, v41
    v_dot2_f32_bf16 v42, v125, s51, v42
    v_dot2_f32_bf16 v43, v125, v125, v43
    v_dot2_f32_bf16 v40, v126, s51, v40
    v_dot2_f32_bf16 v41, v126, v126, v41
    v_dot2_f32_bf16 v42, v127, s51, v42
    v_dot2_f32_bf16 v43, v127, v127, v43
    v_cvt_pk_bf16_f32 v128, v45, v49
    v_cvt_pk_bf16_f32 v129, v53, v57
    v_cvt_pk_bf16_f32 v130, v61, v66
    v_cvt_pk_bf16_f32 v131, v70, v74
    buffer_store_dwordx4 v[128:131], v21, s[8:11], s42 offen offset:256 sc1
    v_dot2_f32_bf16 v40, v128, s51, v40
    v_dot2_f32_bf16 v41, v128, v128, v41
    v_dot2_f32_bf16 v42, v129, s51, v42
    v_dot2_f32_bf16 v43, v129, v129, v43
    v_dot2_f32_bf16 v40, v130, s51, v40
    v_dot2_f32_bf16 v41, v130, v130, v41
    v_dot2_f32_bf16 v42, v131, s51, v42
    v_dot2_f32_bf16 v43, v131, v131, v43
    v_cvt_pk_bf16_f32 v132, v46, v50
    v_cvt_pk_bf16_f32 v133, v54, v58
    v_cvt_pk_bf16_f32 v134, v62, v65
    v_cvt_pk_bf16_f32 v135, v69, v73
    buffer_store_dwordx4 v[132:135], v21, s[8:11], s42 offen offset:512 sc1
    v_dot2_f32_bf16 v40, v132, s51, v40
    v_dot2_f32_bf16 v41, v132, v132, v41
    v_dot2_f32_bf16 v42, v133, s51, v42
    v_dot2_f32_bf16 v43, v133, v133, v43
    v_dot2_f32_bf16 v40, v134, s51, v40
    v_dot2_f32_bf16 v41, v134, v134, v41
    v_dot2_f32_bf16 v42, v135, s51, v42
    v_dot2_f32_bf16 v43, v135, v135, v43
    v_cvt_pk_bf16_f32 v136, v47, v51
    v_cvt_pk_bf16_f32 v137, v55, v59
    v_cvt_pk_bf16_f32 v138, v63, v64
    v_cvt_pk_bf16_f32 v139, v68, v72
    buffer_store_dwordx4 v[136:139], v21, s[8:11], s42 offen offset:768 sc1
    v_dot2_f32_bf16 v40, v136, s51, v40
    v_dot2_f32_bf16 v41, v136, v136, v41
    v_dot2_f32_bf16 v42, v137, s51, v42
    v_dot2_f32_bf16 v43, v137, v137, v43
    v_dot2_f32_bf16 v40, v138, s51, v40
    v_dot2_f32_bf16 v41, v138, v138, v41
    v_dot2_f32_bf16 v42, v139, s51, v42
    v_dot2_f32_bf16 v43, v139, v139, v43
    s_nop 1
    v_add_f32 v40, v40, v42
    v_add_f32 v41, v41, v43
    s_nop 1
    v_permlane32_swap_b32 v40, v41
    v_add_f32 v40, v40, v41
    v_mov_b32 v41, v40
    s_nop 1
    v_permlane16_swap_b32 v40, v41
    v_add_f32 v40, v40, v41
    v_mov_b32 v26, s45
    buffer_store_dword v40, v22, s[8:11], s43 offen sc1
    s_waitcnt vmcnt(6)
    s_barrier
    v_mov_b32 v44, s51
    v_mov_b32 v45, s51
    v_mov_b32 v46, s51
    v_mov_b32 v47, s51
    ds_read_b64_tr_b16 v[56:57], v156 offset:0
    ds_read_b64_tr_b16 v[58:59], v156 offset:1792
    ds_read_b64_tr_b16 v[60:61], v156 offset:32
    ds_read_b64_tr_b16 v[62:63], v156 offset:1824
    ds_read_b64_tr_b16 v[64:65], v156 offset:7168
    ds_read_b64_tr_b16 v[66:67], v156 offset:8960
    ds_read_b64_tr_b16 v[68:69], v156 offset:7200
    ds_read_b64_tr_b16 v[70:71], v156 offset:8992
    ds_read_b64_tr_b16 v[72:73], v156 offset:14336
    ds_read_b64_tr_b16 v[74:75], v156 offset:16128
    ds_read_b64_tr_b16 v[76:77], v156 offset:14368
    ds_read_b64_tr_b16 v[78:79], v156 offset:16160
    s_waitcnt lgkmcnt(8)
    v_mfma_f32_16x16x32_bf16 v[48:51], v[56:59], v[44:47], 0
    v_mfma_f32_16x16x32_bf16 v[52:55], v[60:63], v[44:47], 0
    ds_read_b64_tr_b16 v[80:81], v156 offset:21504
    ds_read_b64_tr_b16 v[82:83], v156 offset:23296
    ds_read_b64_tr_b16 v[84:85], v156 offset:21536
    ds_read_b64_tr_b16 v[86:87], v156 offset:23328
    s_waitcnt lgkmcnt(8)
    v_mfma_f32_16x16x32_bf16 v[48:51], v[64:67], v[44:47], v[48:51]
    v_mfma_f32_16x16x32_bf16 v[52:55], v[68:71], v[44:47], v[52:55]
    ds_read_b64_tr_b16 v[56:57], v156 offset:28672
    ds_read_b64_tr_b16 v[58:59], v156 offset:30464
    ds_read_b64_tr_b16 v[60:61], v156 offset:28704
    ds_read_b64_tr_b16 v[62:63], v156 offset:30496
    s_waitcnt lgkmcnt(8)
    v_mfma_f32_16x16x32_bf16 v[48:51], v[72:75], v[44:47], v[48:51]
    v_mfma_f32_16x16x32_bf16 v[52:55], v[76:79], v[44:47], v[52:55]
    ds_read_b64_tr_b16 v[64:65], v156 offset:35840
    ds_read_b64_tr_b16 v[66:67], v156 offset:37632
    ds_read_b64_tr_b16 v[68:69], v156 offset:35872
    ds_read_b64_tr_b16 v[70:71], v156 offset:37664
    s_waitcnt lgkmcnt(8)
    v_mfma_f32_16x16x32_bf16 v[48:51], v[80:83], v[44:47], v[48:51]
    v_mfma_f32_16x16x32_bf16 v[52:55], v[84:87], v[44:47], v[52:55]
    ds_read_b64_tr_b16 v[72:73], v156 offset:43008
    ds_read_b64_tr_b16 v[74:75], v156 offset:44800
    ds_read_b64_tr_b16 v[76:77], v156 offset:43040
    ds_read_b64_tr_b16 v[78:79], v156 offset:44832
    s_waitcnt lgkmcnt(8)
    v_mfma_f32_16x16x32_bf16 v[48:51], v[56:59], v[44:47], v[48:51]
    v_mfma_f32_16x16x32_bf16 v[52:55], v[60:63], v[44:47], v[52:55]
    ds_read_b64_tr_b16 v[80:81], v156 offset:50176
    ds_read_b64_tr_b16 v[82:83], v156 offset:51968
    ds_read_b64_tr_b16 v[84:85], v156 offset:50208
    ds_read_b64_tr_b16 v[86:87], v156 offset:52000
    s_waitcnt lgkmcnt(8)
    v_mfma_f32_16x16x32_bf16 v[48:51], v[64:67], v[44:47], v[48:51]
    v_mfma_f32_16x16x32_bf16 v[52:55], v[68:71], v[44:47], v[52:55]
    ds_read_b64_tr_b16 v[56:57], v157 offset:0
    ds_read_b64_tr_b16 v[58:59], v157 offset:1792
    ds_read_b64_tr_b16 v[60:61], v157 offset:32
    ds_read_b64_tr_b16 v[62:63], v157 offset:1824
    s_waitcnt lgkmcnt(8)
    v_mfma_f32_16x16x32_bf16 v[48:51], v[72:75], v[44:47], v[48:51]
    v_mfma_f32_16x16x32_bf16 v[52:55], v[76:79], v[44:47], v[52:55]
    ds_read_b64_tr_b16 v[64:65], v157 offset:7168
    ds_read_b64_tr_b16 v[66:67], v157 offset:8960
    ds_read_b64_tr_b16 v[68:69], v157 offset:7200
    ds_read_b64_tr_b16 v[70:71], v157 offset:8992
    s_waitcnt vmcnt(0)
    s_mov_b64 exec, 1
    buffer_atomic_add v5, v26, s[8:11], 0 offen sc1
    s_mov_b64 exec, -1
    v_cmp_ne_u32 vcc, s47, v15
    s_cbranch_vccz Lok28
    s_mov_b64 exec, 1
    s_mov_b32 s63, 100000
Lpoll29:
    buffer_load_dword v15, v11, s[8:11], 0 offen sc1
    s_sub_u32 s63, s63, 1
    s_cbranch_scc1 Lpolld30
    s_waitcnt vmcnt(0)
    v_cmp_ne_u32 vcc, s47, v15
    s_cbranch_vccz Lpolld30
    s_sleep 2
    s_branch Lpoll29
Lpolld30:
    s_waitcnt vmcnt(0)
    s_mov_b64 exec, -1
Lok28:
    s_add_u32 s62, s46, 0
    buffer_load_dwordx4 a[160:163], v4, s[8:11], s62 offen offset:0 sc1
    buffer_load_dwordx4 a[164:167], v4, s[8:11], s62 offen offset:1024 sc1
    buffer_load_dwordx4 a[168:171], v4, s[8:11], s62 offen offset:2048 sc1
    buffer_load_dwordx4 a[172:175], v4, s[8:11], s62 offen offset:3072 sc1
    s_add_u32 s62, s62, 4096
    buffer_load_dwordx4 a[176:179], v4, s[8:11], s62 offen offset:0 sc1
    s_add_u32 s62, s46, 5120
    buffer_load_dwordx4 a[180:183], v4, s[8:11], s62 offen offset:0 sc1
    buffer_load_dwordx4 a[184:187], v4, s[8:11], s62 offen offset:1024 sc1
    buffer_load_dwordx4 a[188:191], v4, s[8:11], s62 offen offset:2048 sc1
    s_waitcnt lgkmcnt(8)
    v_mfma_f32_16x16x32_bf16 v[48:51], v[80:83], v[44:47], v[48:51]
    v_mfma_f32_16x16x32_bf16 v[52:55], v[84:87], v[44:47], v[52:55]
    ds_read_b64_tr_b16 v[72:73], v157 offset:14336
    ds_read_b64_tr_b16 v[74:75], v157 offset:16128
    ds_read_b64_tr_b16 v[76:77], v157 offset:14368
    ds_read_b64_tr_b16 v[78:79], v157 offset:16160
    s_waitcnt lgkmcnt(8)
    v_mfma_f32_16x16x32_bf16 v[48:51], v[56:59], v[44:47], v[48:51]
    v_mfma_f32_16x16x32_bf16 v[52:55], v[60:63], v[44:47], v[52:55]
    ds_read_b64_tr_b16 v[80:81], v157 offset:21504
    ds_read_b64_tr_b16 v[82:83], v157 offset:23296
    ds_read_b64_tr_b16 v[84:85], v157 offset:21536
    ds_read_b64_tr_b16 v[86:87], v157 offset:23328
    buffer_load_dwordx4 a[192:195], v4, s[8:11], s62 offen offset:3072 sc1
    s_waitcnt lgkmcnt(8)
    v_mfma_f32_16x16x32_bf16 v[48:51], v[64:67], v[44:47], v[48:51]
    v_mfma_f32_16x16x32_bf16 v[52:55], v[68:71], v[44:47], v[52:55]
    ds_read_b64_tr_b16 v[56:57], v157 offset:28672
    ds_read_b64_tr_b16 v[58:59], v157 offset:30464
    ds_read_b64_tr_b16 v[60:61], v157 offset:28704
    ds_read_b64_tr_b16 v[62:63], v157 offset:30496
    s_waitcnt lgkmcnt(8)
    v_mfma_f32_16x16x32_bf16 v[48:51], v[72:75], v[44:47], v[48:51]
    v_mfma_f32_16x16x32_bf16 v[52:55], v[76:79], v[44:47], v[52:55]
    ds_read_b64_tr_b16 v[64:65], v157 offset:35840
    ds_read_b64_tr_b16 v[66:67], v157 offset:37632
    ds_read_b64_tr_b16 v[68:69], v157 offset:35872
    ds_read_b64_tr_b16 v[70:71], v157 offset:37664
    s_add_u32 s62, s62, 4096
    buffer_load_dwordx4 a[196:199], v4, s[8:11], s62 offen offset:0 sc1
    s_waitcnt lgkmcnt(8)
    v_mfma_f32_16x16x32_bf16 v[48:51], v[80:83], v[44:47], v[48:51]
    v_mfma_f32_16x16x32_bf16 v[52:55], v[84:87], v[44:47], v[52:55]
    ds_read_b64_tr_b16 v[72:73], v157 offset:43008
    ds_read_b64_tr_b16 v[74:75], v157 offset:44800
    ds_read_b64_tr_b16 v[76:77], v157 offset:43040
    ds_read_b64_tr_b16 v[78:79], v157 offset:44832
    s_waitcnt lgkmcnt(8)
    v_mfma_f32_16x16x32_bf16 v[48:51], v[56:59], v[44:47], v[48:51]
    v_mfma_f32_16x16x32_bf16 v[52:55], v[60:63], v[44:47], v[52:55]
    ds_read_b64_tr_b16 v[80:81], v157 offset:50176
    ds_read_b64_tr_b16 v[82:83], v157 offset:51968
    ds_read_b64_tr_b16 v[84:85], v157 offset:50208
    ds_read_b64_tr_b16 v[86:87], v157 offset:52000
    s_add_u32 s62, s46, 10240
    buffer_load_dwordx4 a[200:203], v4, s[8:11], s62 offen offset:0 sc1
    s_waitcnt lgkmcnt(8)
    v_mfma_f32_16x16x32_bf16 v[48:51], v[64:67], v[44:47], v[48:51]
    v_mfma_f32_16x16x32_bf16 v[52:55], v[68:71], v[44:47], v[52:55]
    ds_read_b64_tr_b16 v[56:57], v158 offset:0
    ds_read_b64_tr_b16 v[58:59], v158 offset:1792
    ds_read_b64_tr_b16 v[60:61], v158 offset:32
    ds_read_b64_tr_b16 v[62:63], v158 offset:1824
    s_waitcnt lgkmcnt(8)
    v_mfma_f32_16x16x32_bf16 v[48:51], v[72:75], v[44:47], v[48:51]
    v_mfma_f32_16x16x32_bf16 v[52:55], v[76:79], v[44:47], v[52:55]
    ds_read_b64_tr_b16 v[64:65], v158 offset:7168
    ds_read_b64_tr_b16 v[66:67], v158 offset:8960
    ds_read_b64_tr_b16 v[68:69], v158 offset:7200
    ds_read_b64_tr_b16 v[70:71], v158 offset:8992
    buffer_load_dwordx4 a[204:207], v4, s[8:11], s62 offen offset:1024 sc1
    s_waitcnt lgkmcnt(8)
    v_mfma_f32_16x16x32_bf16 v[48:51], v[80:83], v[44:47], v[48:51]
    v_mfma_f32_16x16x32_bf16 v[52:55], v[84:87], v[44:47], v[52:55]
    ds_read_b64_tr_b16 v[72:73], v158 offset:14336
    ds_read_b64_tr_b16 v[74:75], v158 offset:16128
    ds_read_b64_tr_b16 v[76:77], v158 offset:14368
    ds_read_b64_tr_b16 v[78:79], v158 offset:16160
    s_waitcnt lgkmcnt(8)
    v_mfma_f32_16x16x32_bf16 v[48:51], v[56:59], v[44:47], v[48:51]
    v_mfma_f32_16x16x32_bf16 v[52:55], v[60:63], v[44:47], v[52:55]
    ds_read_b64_tr_b16 v[80:81], v158 offset:21504
    ds_read_b64_tr_b16 v[82:83], v158 offset:23296
    ds_read_b64_tr_b16 v[84:85], v158 offset:21536
    ds_read_b64_tr_b16 v[86:87], v158 offset:23328
    buffer_load_dwordx4 a[208:211], v4, s[8:11], s62 offen offset:2048 sc1
    s_waitcnt lgkmcnt(8)
    v_mfma_f32_16x16x32_bf16 v[48:51], v[64:67], v[44:47], v[48:51]
    v_mfma_f32_16x16x32_bf16 v[52:55], v[68:71], v[44:47], v[52:55]
    s_waitcnt lgkmcnt(4)
    v_mfma_f32_16x16x32_bf16 v[48:51], v[72:75], v[44:47], v[48:51]
    v_mfma_f32_16x16x32_bf16 v[52:55], v[76:79], v[44:47], v[52:55]
    buffer_load_dwordx4 a[212:215], v4, s[8:11], s62 offen offset:3072 sc1
    s_waitcnt lgkmcnt(0)
    v_mfma_f32_16x16x32_bf16 v[48:51], v[80:83], v[44:47], v[48:51]
    v_mfma_f32_16x16x32_bf16 v[52:55], v[84:87], v[44:47], v[52:55]
    s_lshl_b32 s3, s20, 11
    s_add_u32 s3, s3, 143360
    v_add_u32 v6, s3, v4
    s_nop 3
    ds_write_b128 v6, v[48:51]
    ds_write_b128 v6, v[52:55] offset:1024
    v_add_u32 v6, 143360, v4
    s_waitcnt lgkmcnt(0)
    s_barrier
    ds_read_b128 v[16:19], v6 offset:0
    ds_read_b128 v[20:23], v6 offset:1024
    ds_read_b128 v[24:27], v6 offset:2048
    ds_read_b128 v[28:31], v6 offset:3072
    ds_read_b128 v[32:35], v6 offset:4096
    ds_read_b128 v[36:39], v6 offset:5120
    ds_read_b128 v[40:43], v6 offset:6144
    s_add_u32 s62, s62, 4096
    buffer_load_dwordx4 a[216:219], v4, s[8:11], s62 offen offset:0 sc1
    s_add_u32 s62, s46, 15360
    buffer_load_dwordx4 a[220:223], v4, s[8:11], s62 offen offset:0 sc1
    buffer_load_dwordx4 a[224:227], v4, s[8:11], s62 offen offset:1024 sc1
    buffer_load_dwordx4 a[228:231], v4, s[8:11], s62 offen offset:2048 sc1
    buffer_load_dwordx4 a[232:235], v4, s[8:11], s62 offen offset:3072 sc1
    s_add_u32 s62, s62, 4096
    buffer_load_dwordx4 a[236:239], v4, s[8:11], s62 offen offset:0 sc1
    s_waitcnt lgkmcnt(0)
    s_branch LB_join
LB_idle:
    v_bfe_u32 v8, v1, 2, 3
    v_lshlrev_b32 v8, 7, v8
    v_lshrrev_b32 v9, 5, v1
    s_movk_i32 s3, 5120
    v_mad_u32_u24 v8, v9, s3, v8
    v_add_u32 v8, 122880, v8
    v_and_b32 v9, 3, v1
    v_lshl_add_u32 v16, v9, 4, v8
    v_add_u32 v16, s52, v16
    v_lshl_add_u32 v17, v9, 3, v8
    v_lshl_add_u32 v17, s20, 5, v17
    s_waitcnt vmcnt(3)
    s_barrier
    s_cmp_lg_u32 s41, 2147483648
    s_cbranch_scc0 Lopt31
    ds_read_b64_tr_b16 v[176:177], v16 offset:0
    ds_read_b64_tr_b16 v[178:179], v16 offset:10240
    ds_read_b64_tr_b16 v[180:181], v16 offset:8
    ds_read_b64_tr_b16 v[182:183], v16 offset:10248
    ds_read_b64_tr_b16 v[184:185], v16 offset:64
    ds_read_b64_tr_b16 v[186:187], v16 offset:10304
    ds_read_b64_tr_b16 v[188:189], v16 offset:72
    ds_read_b64_tr_b16 v[190:191], v16 offset:10312
    ds_read_b64_tr_b16 v[192:193], v17 offset:4096
    ds_read_b64_tr_b16 v[194:195], v17 offset:14336
    s_waitcnt lgkmcnt(0)
    buffer_store_dwordx4 v[176:179], v4, s[8:11], s40 offen offset:0 sc1
    buffer_store_dwordx4 v[180:183], v4, s[8:11], s40 offen offset:1024 sc1
    buffer_store_dwordx4 v[184:187], v4, s[8:11], s40 offen offset:2048 sc1
    buffer_store_dwordx4 v[188:191], v4, s[8:11], s40 offen offset:3072 sc1
    s_add_u32 s40, s40, 4096
    buffer_store_dwordx4 v[192:195], v4, s[8:11], s40 offen sc1
    s_nop 1
Lopt31:
    s_cmp_lg_u32 s43, 2147483648
    s_cbranch_scc0 Lopt32
    ds_read_b64_tr_b16 v[176:177], v16 offset:20480
    ds_read_b64_tr_b16 v[178:179], v16 offset:30720
    ds_read_b64_tr_b16 v[180:181], v16 offset:20488
    ds_read_b64_tr_b16 v[182:183], v16 offset:30728
    ds_read_b64_tr_b16 v[184:185], v16 offset:20544
    ds_read_b64_tr_b16 v[186:187], v16 offset:30784
    ds_read_b64_tr_b16 v[188:189], v16 offset:20552
    ds_read_b64_tr_b16 v[190:191], v16 offset:30792
    ds_read_b64_tr_b16 v[192:193], v17 offset:24576
    ds_read_b64_tr_b16 v[194:195], v17 offset:34816
    s_waitcnt lgkmcnt(0)
    buffer_store_dwordx4 v[176:179], v4, s[8:11], s42 offen offset:0 sc1
    buffer_store_dwordx4 v[180:183], v4, s[8:11], s42 offen offset:1024 sc1
    buffer_store_dwordx4 v[184:187], v4, s[8:11], s42 offen offset:2048 sc1
    buffer_store_dwordx4 v[188:191], v4, s[8:11], s42 offen offset:3072 sc1
    s_add_u32 s42, s42, 4096
    buffer_store_dwordx4 v[192:195], v4, s[8:11], s42 offen sc1
    s_nop 1
Lopt32:
    s_add_u32 m0, s53, 6144
    s_nop 0
    buffer_load_dwordx4 v166, s[24:27], s33 offen  lds
    s_mov_b32 s53, 2
    s_mul_i32 s33, s53, 442368
    s_add_u32 s33, s33, s32
    s_mul_i32 s53, s53, 28672
    s_add_u32 s53, s53, s55
    s_add_u32 m0, s53, 0
    s_nop 0
    buffer_load_dwordx4 v160, s[24:27], s33 offen  lds
    s_add_u32 m0, s53, 1024
    s_nop 0
    buffer_load_dwordx4 v161, s[24:27], s33 offen  lds
    s_add_u32 m0, s53, 2048
    s_nop 0
    buffer_load_dwordx4 v162, s[24:27], s33 offen  lds
    s_add_u32 m0, s53, 3072
    s_nop 0
    buffer_load_dwordx4 v163, s[24:27], s33 offen  lds
    s_add_u32 m0, s53, 4096
    s_nop 0
    buffer_load_dwordx4 v164, s[24:27], s33 offen  lds
    s_add_u32 m0, s53, 5120
    s_nop 0
    buffer_load_dwordx4 v165, s[24:27], s33 offen  lds
    s_add_u32 m0, s53, 6144
    s_nop 0
    buffer_load_dwordx4 v166, s[24:27], s33 offen  lds
    s_mov_b32 s53, 0
    s_mul_i32 s33, s53, 442368
    s_add_u32 s33, s33, s32
    s_mul_i32 s53, s53, 28672
    s_add_u32 s53, s53, s55
    s_add_u32 m0, s53, 0
    s_nop 0
    buffer_load_dwordx4 v160, s[24:27], s33 offen  lds
    s_add_u32 m0, s53, 1024
    s_nop 0
    buffer_load_dwordx4 v161, s[24:27], s33 offen  lds
    s_waitcnt vmcnt(10)
    v_mov_b32 v8, s41
    v_mov_b32 v9, s43
    s_mov_b64 exec, 1
    buffer_atomic_add v5, v8, s[8:11], 0 offen sc1
    s_mov_b64 exec, -1
    s_mov_b64 exec, 1
    buffer_atomic_add v5, v9, s[8:11], 0 offen sc1
    s_mov_b64 exec, -1
    v_lshrrev_b32 v6, 5, v1
    v_bfe_u32 v7, v1, 2, 3
    v_lshl_add_u32 v6, v6, 4, v7
    v_mul_u32_u24 v6, 224, v6
    v_and_b32 v7, 3, v1
    v_lshl_add_u32 v6, v7, 3, v6
    s_lshl_b32 s3, s31, 5
    v_add_u32 v168, s3, v6
    s_add_u32 m0, s53, 2048
    s_nop 0
    buffer_load_dwordx4 v162, s[24:27], s33 offen  lds
    v_add_u32 v169, 57344, v168
    v_add_u32 v170, 114688, v168
    s_cmp_eq_u32 s31, 0
    s_cselect_b32 s3, 192, 0
    v_add_u32 v171, s3, v6
    v_add_u32 v172, 57344, v171
    v_add_u32 v173, 114688, v171
    s_lshl_b32 s3, s20, 6
    s_add_u32 m0, s53, 3072
    s_nop 0
    buffer_load_dwordx4 v163, s[24:27], s33 offen  lds
    s_cmp_eq_u32 s20, 3
    s_cselect_b64 vcc, -1, 0
    s_cselect_b32 s0, 2147483648, 0
    v_or_b32 v10, s0, v4
    v_add_u32 v156, s3, v168
    v_cndmask_b32 v156, v156, v171, vcc
    v_add_u32 v157, s3, v169
    v_cndmask_b32 v157, v157, v172, vcc
    s_add_u32 m0, s53, 4096
    s_nop 0
    buffer_load_dwordx4 v164, s[24:27], s33 offen  lds
    v_add_u32 v158, s3, v170
    v_cndmask_b32 v158, v158, v173, vcc
    v_lshlrev_b32 v167, 3, v3
    v_lshl_add_u32 v167, v2, 7, v167
    v_cmp_le_u32 vcc, 16, v1
    s_nop 1
    v_cndmask_b32 v6, 0, v5, vcc
    v_lshl_or_b32 v13, v6, 31, v167
    v_lshrrev_b32 v14, 1, v4
    s_add_u32 m0, s53, 5120
    s_nop 0
    buffer_load_dwordx4 v165, s[24:27], s33 offen  lds
    v_or_b32 v14, s0, v14
    s_lshl_b32 s0, s60, 3
    s_lshl_b32 s3, s20, 1
    s_add_u32 s0, s0, s3
    s_lshl_b32 s23, s0, 10
    s_add_u32 s23, s23, 14680064
    s_mul_i32 s21, s0, 20480
    s_add_u32 s21, s21, 11534336
    s_add_u32 m0, s53, 6144
    s_nop 0
    buffer_load_dwordx4 v166, s[24:27], s33 offen  lds
    s_add_u32 s22, s21, 20480
    s_lshr_b32 s3, s0, 1
    s_add_u32 s3, s3, 192
    s_lshl_b32 s3, s3, 8
    v_mov_b32 v174, s3
    s_lshr_b32 s1, s61, 2
    s_cmp_lt_u32 s1, 3
    s_cselect_b32 s3, 0, 2147483648
    v_lshrrev_b32 v175, 1, v4
    s_mov_b32 s53, 1
    s_mul_i32 s33, s53, 442368
    s_add_u32 s33, s33, s32
    s_mul_i32 s53, s53, 28672
    s_add_u32 s53, s53, s55
    s_add_u32 m0, s53, 0
    s_nop 0
    buffer_load_dwordx4 v160, s[24:27], s33 offen  lds
    v_or_b32 v175, s3, v175
    s_and_b32 s48, s0, 0xfc
    s_add_u32 s48, s48, s1
    s_lshl_b32 s48, s48, 1
    s_add_u32 s48, s48, 256
    s_lshl_b32 s48, s48, 8
    s_mul_i32 s1, s1, 14
    s_mul_i32 s0, s0, 56
    s_add_u32 m0, s53, 1024
    s_nop 0
    buffer_load_dwordx4 v161, s[24:27], s33 offen  lds
    s_add_u32 s0, s0, s1
    s_lshl_b32 s0, s0, 10
    s_add_u32 s0, s0, 16777216
    s_and_b32 s1, s61, 3
    s_lshl_b32 s12, s1, 11
    s_add_u32 s12, s12, s0
    s_add_u32 s13, s12, 1024
    s_add_u32 s14, s1, 10
    s_add_u32 m0, s53, 2048
    s_nop 0
    buffer_load_dwordx4 v162, s[24:27], s33 offen  lds
    s_lshl_b32 s14, s14, 10
    s_add_u32 s14, s14, s0
    s_lshr_b32 s15, s1, 1
    s_add_u32 s15, s15, 8
    s_lshl_b32 s15, s15, 10
    s_add_u32 s15, s15, s0
    s_lshl_b32 s3, s31, 9
    s_add_u32 s15, s15, s3
    s_add_u32 m0, s53, 3072
    s_nop 0
    buffer_load_dwordx4 v163, s[24:27], s33 offen  lds
    s_add_u32 m0, s53, 4096
    s_nop 0
    buffer_load_dwordx4 v164, s[24:27], s33 offen  lds
    s_add_u32 m0, s53, 5120
    s_nop 0
    buffer_load_dwordx4 v165, s[24:27], s33 offen  lds
    s_add_u32 m0, s53, 6144
    s_nop 0
    buffer_load_dwordx4 v166, s[24:27], s33 offen  lds
    s_barrier
    s_mov_b32 s53, 4
    s_mul_i32 s33, s53, 442368
    s_add_u32 s33, s33, s32
    s_mul_i32 s53, s53, 28672
    s_add_u32 s53, s53, s55
    s_add_u32 m0, s53, 0
    s_nop 0
    buffer_load_dwordx4 v160, s[24:27], s33 offen  lds
    s_add_u32 m0, s53, 1024
    s_nop 0
    buffer_load_dwordx4 v161, s[24:27], s33 offen  lds
    s_add_u32 m0, s53, 2048
    s_nop 0
    buffer_load_dwordx4 v162, s[24:27], s33 offen  lds
    s_add_u32 m0, s53, 3072
    s_nop 0
    buffer_load_dwordx4 v163, s[24:27], s33 offen  lds
    s_add_u32 m0, s53, 4096
    s_nop 0
    buffer_load_dwordx4 v164, s[24:27], s33 offen  lds
    s_add_u32 m0, s53, 5120
    s_nop 0
    buffer_load_dwordx4 v165, s[24:27], s33 offen  lds
    s_add_u32 m0, s53, 6144
    s_nop 0
    buffer_load_dwordx4 v166, s[24:27], s33 offen  lds
    buffer_load_dword v15, v11, s[8:11], 0 offen sc1
    s_waitcnt vmcnt(0)
    v_cmp_ne_u32 vcc, s47, v15
    s_cbranch_vccz Lok33
    s_mov_b64 exec, 1
    s_mov_b32 s63, 100000
Lpoll34:
    buffer_load_dword v15, v11, s[8:11], 0 offen sc1
    s_sub_u32 s63, s63, 1
    s_cbranch_scc1 Lpolld35
    s_waitcnt vmcnt(0)
    v_cmp_ne_u32 vcc, s47, v15
    s_cbranch_vccz Lpolld35
    s_sleep 3
    s_branch Lpoll34
Lpolld35:
    s_waitcnt vmcnt(0)
    s_mov_b64 exec, -1
Lok33:
    s_barrier
    v_mov_b32 v44, s51
    v_mov_b32 v45, s51
    v_mov_b32 v46, s51
    v_mov_b32 v47, s51
    ds_read_b64_tr_b16 v[56:57], v156 offset:0
    ds_read_b64_tr_b16 v[58:59], v156 offset:1792
    ds_read_b64_tr_b16 v[60:61], v156 offset:32
    ds_read_b64_tr_b16 v[62:63], v156 offset:1824
    ds_read_b64_tr_b16 v[64:65], v156 offset:7168
    ds_read_b64_tr_b16 v[66:67], v156 offset:8960
    ds_read_b64_tr_b16 v[68:69], v156 offset:7200
    ds_read_b64_tr_b16 v[70:71], v156 offset:8992
    ds_read_b64_tr_b16 v[72:73], v156 offset:14336
    ds_read_b64_tr_b16 v[74:75], v156 offset:16128
    ds_read_b64_tr_b16 v[76:77], v156 offset:14368
    ds_read_b64_tr_b16 v[78:79], v156 offset:16160
    s_waitcnt lgkmcnt(8)
    v_mfma_f32_16x16x32_bf16 v[48:51], v[56:59], v[44:47], 0
    v_mfma_f32_16x16x32_bf16 v[52:55], v[60:63], v[44:47], 0
    ds_read_b64_tr_b16 v[80:81], v156 offset:21504
    ds_read_b64_tr_b16 v[82:83], v156 offset:23296
    ds_read_b64_tr_b16 v[84:85], v156 offset:21536
    ds_read_b64_tr_b16 v[86:87], v156 offset:23328
    s_waitcnt lgkmcnt(8)
    v_mfma_f32_16x16x32_bf16 v[48:51], v[64:67], v[44:47], v[48:51]
    v_mfma_f32_16x16x32_bf16 v[52:55], v[68:71], v[44:47], v[52:55]
    ds_read_b64_tr_b16 v[56:57], v156 offset:28672
    ds_read_b64_tr_b16 v[58:59], v156 offset:30464
    ds_read_b64_tr_b16 v[60:61], v156 offset:28704
    ds_read_b64_tr_b16 v[62:63], v156 offset:30496
    s_waitcnt lgkmcnt(8)
    v_mfma_f32_16x16x32_bf16 v[48:51], v[72:75], v[44:47], v[48:51]
    v_mfma_f32_16x16x32_bf16 v[52:55], v[76:79], v[44:47], v[52:55]
    ds_read_b64_tr_b16 v[64:65], v156 offset:35840
    ds_read_b64_tr_b16 v[66:67], v156 offset:37632
    ds_read_b64_tr_b16 v[68:69], v156 offset:35872
    ds_read_b64_tr_b16 v[70:71], v156 offset:37664
    s_waitcnt lgkmcnt(8)
    v_mfma_f32_16x16x32_bf16 v[48:51], v[80:83], v[44:47], v[48:51]
    v_mfma_f32_16x16x32_bf16 v[52:55], v[84:87], v[44:47], v[52:55]
    ds_read_b64_tr_b16 v[72:73], v156 offset:43008
    ds_read_b64_tr_b16 v[74:75], v156 offset:44800
    ds_read_b64_tr_b16 v[76:77], v156 offset:43040
    ds_read_b64_tr_b16 v[78:79], v156 offset:44832
    s_waitcnt lgkmcnt(8)
    v_mfma_f32_16x16x32_bf16 v[48:51], v[56:59], v[44:47], v[48:51]
    v_mfma_f32_16x16x32_bf16 v[52:55], v[60:63], v[44:47], v[52:55]
    ds_read_b64_tr_b16 v[80:81], v156 offset:50176
    ds_read_b64_tr_b16 v[82:83], v156 offset:51968
    ds_read_b64_tr_b16 v[84:85], v156 offset:50208
    ds_read_b64_tr_b16 v[86:87], v156 offset:52000
    s_waitcnt lgkmcnt(8)
    v_mfma_f32_16x16x32_bf16 v[48:51], v[64:67], v[44:47], v[48:51]
    v_mfma_f32_16x16x32_bf16 v[52:55], v[68:71], v[44:47], v[52:55]
    ds_read_b64_tr_b16 v[56:57], v157 offset:0
    ds_read_b64_tr_b16 v[58:59], v157 offset:1792
    ds_read_b64_tr_b16 v[60:61], v157 offset:32
    ds_read_b64_tr_b16 v[62:63], v157 offset:1824
    s_waitcnt lgkmcnt(8)
    v_mfma_f32_16x16x32_bf16 v[48:51], v[72:75], v[44:47], v[48:51]
    v_mfma_f32_16x16x32_bf16 v[52:55], v[76:79], v[44:47], v[52:55]
    ds_read_b64_tr_b16 v[64:65], v157 offset:7168
    ds_read_b64_tr_b16 v[66:67], v157 offset:8960
    ds_read_b64_tr_b16 v[68:69], v157 offset:7200
    ds_read_b64_tr_b16 v[70:71], v157 offset:8992
    s_add_u32 s62, s46, 0
    buffer_load_dwordx4 a[160:163], v4, s[8:11], s62 offen offset:0 sc1
    buffer_load_dwordx4 a[164:167], v4, s[8:11], s62 offen offset:1024 sc1
    buffer_load_dwordx4 a[168:171], v4, s[8:11], s62 offen offset:2048 sc1
    buffer_load_dwordx4 a[172:175], v4, s[8:11], s62 offen offset:3072 sc1
    s_add_u32 s62, s62, 4096
    buffer_load_dwordx4 a[176:179], v4, s[8:11], s62 offen offset:0 sc1
    s_add_u32 s62, s46, 5120
    buffer_load_dwordx4 a[180:183], v4, s[8:11], s62 offen offset:0 sc1
    buffer_load_dwordx4 a[184:187], v4, s[8:11], s62 offen offset:1024 sc1
    buffer_load_dwordx4 a[188:191], v4, s[8:11], s62 offen offset:2048 sc1
    s_waitcnt lgkmcnt(8)
    v_mfma_f32_16x16x32_bf16 v[48:51], v[80:83], v[44:47], v[48:51]
    v_mfma_f32_16x16x32_bf16 v[52:55], v[84:87], v[44:47], v[52:55]
    ds_read_b64_tr_b16 v[72:73], v157 offset:14336
    ds_read_b64_tr_b16 v[74:75], v157 offset:16128
    ds_read_b64_tr_b16 v[76:77], v157 offset:14368
    ds_read_b64_tr_b16 v[78:79], v157 offset:16160
    s_waitcnt lgkmcnt(8)
    v_mfma_f32_16x16x32_bf16 v[48:51], v[56:59], v[44:47], v[48:51]
    v_mfma_f32_16x16x32_bf16 v[52:55], v[60:63], v[44:47], v[52:55]
    ds_read_b64_tr_b16 v[80:81], v157 offset:21504
    ds_read_b64_tr_b16 v[82:83], v157 offset:23296
    ds_read_b64_tr_b16 v[84:85], v157 offset:21536
    ds_read_b64_tr_b16 v[86:87], v157 offset:23328
    buffer_load_dwordx4 a[192:195], v4, s[8:11], s62 offen offset:3072 sc1
    s_waitcnt lgkmcnt(8)
    v_mfma_f32_16x16x32_bf16 v[48:51], v[64:67], v[44:47], v[48:51]
    v_mfma_f32_16x16x32_bf16 v[52:55], v[68:71], v[44:47], v[52:55]
    ds_read_b64_tr_b16 v[56:57], v157 offset:28672
    ds_read_b64_tr_b16 v[58:59], v157 offset:30464
    ds_read_b64_tr_b16 v[60:61], v157 offset:28704
    ds_read_b64_tr_b16 v[62:63], v157 offset:30496
    s_waitcnt lgkmcnt(8)
    v_mfma_f32_16x16x32_bf16 v[48:51], v[72:75], v[44:47], v[48:51]
    v_mfma_f32_16x16x32_bf16 v[52:55], v[76:79], v[44:47], v[52:55]
    ds_read_b64_tr_b16 v[64:65], v157 offset:35840
    ds_read_b64_tr_b16 v[66:67], v157 offset:37632
    ds_read_b64_tr_b16 v[68:69], v157 offset:35872
    ds_read_b64_tr_b16 v[70:71], v157 offset:37664
    s_add_u32 s62, s62, 4096
    buffer_load_dwordx4 a[196:199], v4, s[8:11], s62 offen offset:0 sc1
    s_waitcnt lgkmcnt(8)
    v_mfma_f32_16x16x32_bf16 v[48:51], v[80:83], v[44:47], v[48:51]
    v_mfma_f32_16x16x32_bf16 v[52:55], v[84:87], v[44:47], v[52:55]
    ds_read_b64_tr_b16 v[72:73], v157 offset:43008
    ds_read_b64_tr_b16 v[74:75], v157 offset:44800
    ds_read_b64_tr_b16 v[76:77], v157 offset:43040
    ds_read_b64_tr_b16 v[78:79], v157 offset:44832
    s_waitcnt lgkmcnt(8)
    v_mfma_f32_16x16x32_bf16 v[48:51], v[56:59], v[44:47], v[48:51]
    v_mfma_f32_16x16x32_bf16 v[52:55], v[60:63], v[44:47], v[52:55]
    ds_read_b64_tr_b16 v[80:81], v157 offset:50176
    ds_read_b64_tr_b16 v[82:83], v157 offset:51968
    ds_read_b64_tr_b16 v[84:85], v157 offset:50208
    ds_read_b64_tr_b16 v[86:87], v157 offset:52000
    s_add_u32 s62, s46, 10240
    buffer_load_dwordx4 a[200:203], v4, s[8:11], s62 offen offset:0 sc1
    s_waitcnt lgkmcnt(8)
    v_mfma_f32_16x16x32_bf16 v[48:51], v[64:67], v[44:47], v[48:51]
    v_mfma_f32_16x16x32_bf16 v[52:55], v[68:71], v[44:47], v[52:55]
    ds_read_b64_tr_b16 v[56:57], v158 offset:0
    ds_read_b64_tr_b16 v[58:59], v158 offset:1792
    ds_read_b64_tr_b16 v[60:61], v158 offset:32
    ds_read_b64_tr_b16 v[62:63], v158 offset:1824
    s_waitcnt lgkmcnt(8)
    v_mfma_f32_16x16x32_bf16 v[48:51], v[72:75], v[44:47], v[48:51]
    v_mfma_f32_16x16x32_bf16 v[52:55], v[76:79], v[44:47], v[52:55]
    ds_read_b64_tr_b16 v[64:65], v158 offset:7168
    ds_read_b64_tr_b16 v[66:67], v158 offset:8960
    ds_read_b64_tr_b16 v[68:69], v158 offset:7200
    ds_read_b64_tr_b16 v[70:71], v158 offset:8992
    buffer_load_dwordx4 a[204:207], v4, s[8:11], s62 offen offset:1024 sc1
    s_waitcnt lgkmcnt(8)
    v_mfma_f32_16x16x32_bf16 v[48:51], v[80:83], v[44:47], v[48:51]
    v_mfma_f32_16x16x32_bf16 v[52:55], v[84:87], v[44:47], v[52:55]
    ds_read_b64_tr_b16 v[72:73], v158 offset:14336
    ds_read_b64_tr_b16 v[74:75], v158 offset:16128
    ds_read_b64_tr_b16 v[76:77], v158 offset:14368
    ds_read_b64_tr_b16 v[78:79], v158 offset:16160
    s_waitcnt lgkmcnt(8)
    v_mfma_f32_16x16x32_bf16 v[48:51], v[56:59], v[44:47], v[48:51]
    v_mfma_f32_16x16x32_bf16 v[52:55], v[60:63], v[44:47], v[52:55]
    ds_read_b64_tr_b16 v[80:81], v158 offset:21504
    ds_read_b64_tr_b16 v[82:83], v158 offset:23296
    ds_read_b64_tr_b16 v[84:85], v158 offset:21536
    ds_read_b64_tr_b16 v[86:87], v158 offset:23328
    buffer_load_dwordx4 a[208:211], v4, s[8:11], s62 offen offset:2048 sc1
    s_waitcnt lgkmcnt(8)
    v_mfma_f32_16x16x32_bf16 v[48:51], v[64:67], v[44:47], v[48:51]
    v_mfma_f32_16x16x32_bf16 v[52:55], v[68:71], v[44:47], v[52:55]
    s_waitcnt lgkmcnt(4)
    v_mfma_f32_16x16x32_bf16 v[48:51], v[72:75], v[44:47], v[48:51]
    v_mfma_f32_16x16x32_bf16 v[52:55], v[76:79], v[44:47], v[52:55]
    buffer_load_dwordx4 a[212:215], v4, s[8:11], s62 offen offset:3072 sc1
    s_waitcnt lgkmcnt(0)
    v_mfma_f32_16x16x32_bf16 v[48:51], v[80:83], v[44:47], v[48:51]
    v_mfma_f32_16x16x32_bf16 v[52:55], v[84:87], v[44:47], v[52:55]
    s_lshl_b32 s3, s20, 11
    s_add_u32 s3, s3, 143360
    v_add_u32 v6, s3, v4
    s_nop 3
    ds_write_b128 v6, v[48:51]
    ds_write_b128 v6, v[52:55] offset:1024
    v_add_u32 v6, 143360, v4
    s_waitcnt lgkmcnt(0)
    s_barrier
    ds_read_b128 v[16:19], v6 offset:0
    ds_read_b128 v[20:23], v6 offset:1024
    ds_read_b128 v[24:27], v6 offset:2048
    ds_read_b128 v[28:31], v6 offset:3072
    ds_read_b128 v[32:35], v6 offset:4096
    ds_read_b128 v[36:39], v6 offset:5120
    ds_read_b128 v[40:43], v6 offset:6144
    s_add_u32 s62, s62, 4096
    buffer_load_dwordx4 a[216:219], v4, s[8:11], s62 offen offset:0 sc1
    s_add_u32 s62, s46, 15360
    buffer_load_dwordx4 a[220:223], v4, s[8:11], s62 offen offset:0 sc1
    buffer_load_dwordx4 a[224:227], v4, s[8:11], s62 offen offset:1024 sc1
    buffer_load_dwordx4 a[228:231], v4, s[8:11], s62 offen offset:2048 sc1
    buffer_load_dwordx4 a[232:235], v4, s[8:11], s62 offen offset:3072 sc1
    s_add_u32 s62, s62, 4096
    buffer_load_dwordx4 a[236:239], v4, s[8:11], s62 offen offset:0 sc1
    s_waitcnt lgkmcnt(0)
LB_join:
    ds_read_b64_tr_b16 v[100:101], v168 offset:0
    ds_read_b64_tr_b16 v[102:103], v168 offset:1792
    ds_read_b64_tr_b16 v[104:105], v168 offset:32
    ds_read_b64_tr_b16 v[106:107], v168 offset:1824
    ds_read_b64_tr_b16 v[108:109], v168 offset:64
    ds_read_b64_tr_b16 v[110:111], v168 offset:1856
    ds_read_b64_tr_b16 v[112:113], v168 offset:96
    ds_read_b64_tr_b16 v[114:115], v168 offset:1888
    ds_read_b64_tr_b16 v[116:117], v168 offset:128
    ds_read_b64_tr_b16 v[118:119], v168 offset:1920
    ds_read_b64_tr_b16 v[120:121], v168 offset:160
    ds_read_b64_tr_b16 v[122:123], v168 offset:1952
    ds_read_b64_tr_b16 v[124:125], v171 offset:0
    ds_read_b64_tr_b16 v[126:127], v171 offset:1792
    s_mov_b64 exec, 1
    s_mov_b32 s63, 100000
Lpoll36:
    buffer_load_dword v7, v174, s[8:11], 0 offen sc1
    s_sub_u32 s63, s63, 1
    s_cbranch_scc1 Lpolld37
    s_waitcnt vmcnt(0)
    v_cmp_ne_u32 vcc, 10, v7
    s_cbranch_vccz Lpolld37
    s_sleep 2
    s_branch Lpoll36
Lpolld37:
    s_waitcnt vmcnt(0)
    s_mov_b64 exec, -1
    buffer_load_dwordx2 v[132:133], v167, s[8:11], s23 offen offset:0 sc1
    buffer_load_dwordx2 v[134:135], v13, s[8:11], s23 offen offset:512 sc1
    buffer_load_dwordx2 v[136:137], v167, s[8:11], s23 offen offset:1024 sc1
    buffer_load_dwordx2 v[138:139], v13, s[8:11], s23 offen offset:1536 sc1
    buffer_load_dwordx4 a[0:3], v4, s[8:11], s21 offen offset:0 sc1
    buffer_load_dwordx4 a[4:7], v4, s[8:11], s22 offen offset:0 sc1
    buffer_load_dwordx4 a[8:11], v4, s[8:11], s21 offen offset:1024 sc1
    s_lshr_b32 s31, s50, 3
    s_lshl_b32 s31, s31, 2
    s_and_b32 s3, s50, 3
    s_or_b32 s31, s31, s3
    s_bfe_u32 s30, s50, 0x10002
    s_lshl_b32 s33, s60, 3
    s_lshl_b32 s34, s30, 2
    s_add_u32 s33, s33, s34
    s_add_u32 s38, s33, s20
    s_lshl_b32 s3, s38, 1
    buffer_load_dwordx4 a[12:15], v4, s[8:11], s22 offen offset:1024 sc1
    s_add_u32 s3, s3, 256
    s_lshl_b32 s3, s3, 8
    v_mov_b32 v162, s3
    s_mul_i32 s39, s20, 14
    s_and_b32 s3, s31, 3
    s_add_u32 s3, s3, s33
    s_mul_i32 s3, s3, 56
    s_add_u32 s3, s3, s39
    s_lshl_b32 s3, s3, 10
    s_add_u32 s42, s3, 16777216
    buffer_load_dwordx4 a[16:19], v4, s[8:11], s21 offen offset:2048 sc1
    s_lshr_b32 s3, s31, 2
    s_lshl_b32 s3, s3, 9
    v_lshlrev_b32 v164, 7, v1
    s_add_u32 s3, s20, 1
    s_and_b32 s3, s3, 3
    s_mul_i32 s40, s3, 15360
    s_add_u32 s3, s3, s33
    s_mul_i32 s3, s3, 56
    s_add_u32 s3, s3, s39
    s_lshl_b32 s3, s3, 10
    buffer_load_dwordx4 a[20:23], v4, s[8:11], s22 offen offset:2048 sc1
    s_add_u32 s34, s3, 16777216
    v_add_u32 v158, s40, v4
    s_add_u32 s3, s20, 2
    s_and_b32 s3, s3, 3
    s_mul_i32 s40, s3, 15360
    s_add_u32 s3, s3, s33
    s_mul_i32 s3, s3, 56
    s_add_u32 s3, s3, s39
    s_lshl_b32 s3, s3, 10
    s_add_u32 s35, s3, 16777216
    buffer_load_dwordx4 a[24:27], v4, s[8:11], s21 offen offset:3072 sc1
    s_add_u32 s21, s21, 4096
    v_add_u32 v159, s40, v4
    s_add_u32 s3, s20, 3
    s_and_b32 s3, s3, 3
    s_mul_i32 s40, s3, 15360
    s_add_u32 s3, s3, s33
    s_mul_i32 s3, s3, 56
    s_add_u32 s3, s3, s39
    s_lshl_b32 s3, s3, 10
    s_add_u32 s36, s3, 16777216
    v_add_u32 v160, s40, v4
    buffer_load_dwordx4 a[28:31], v4, s[8:11], s22 offen offset:3072 sc1
    s_add_u32 s22, s22, 4096
    s_add_u32 s3, s20, 4
    s_and_b32 s3, s3, 3
    s_mul_i32 s40, s3, 15360
    s_add_u32 s3, s3, s33
    s_mul_i32 s3, s3, 56
    s_add_u32 s3, s3, s39
    s_lshl_b32 s3, s3, 10
    s_add_u32 s37, s3, 16777216
    v_add_u32 v161, s40, v4
    v_lshlrev_b32 v157, 4, v3
    buffer_load_dwordx4 a[32:35], v4, s[8:11], s21 offen offset:0 sc1
    v_lshl_add_u32 v156, v2, 8, v157
    v_lshrrev_b32 v6, 5, v1
    v_lshl_add_u32 v157, v6, 8, v157
    v_and_b32 v6, 1, v2
    v_lshl_add_u32 v157, v6, 3, v157
    s_lshl_b32 s41, s38, 10
    s_add_u32 s41, s41, 14680064
    s_mul_i32 s40, s38, 20480
    s_add_u32 s40, s40, 11534336
    s_lshl_b32 s3, s31, 9
    buffer_load_dwordx4 a[36:39], v4, s[8:11], s22 offen offset:0 sc1
    s_add_u32 s43, s40, s3
    s_add_u32 s43, s43, 16384
    s_lshl_b32 s3, s31, 11
    s_add_u32 s40, s40, s3
    s_sub_u32 s3, 32, s60
    s_cmp_eq_u32 s60, 0
    s_cselect_b32 s3, 16, s3
    s_cmp_eq_u32 s30, 0
    s_cselect_b32 s39, s60, s3
    v_lshl_add_u32 v165, s20, 4, v3
    v_lshl_add_u32 v165, v165, 5, s39
    v_mul_u32_u24 v165, 1280, v165
    v_lshl_add_u32 v166, v2, 3, v165
    v_lshl_add_u32 v165, v2, 4, v165
    s_lshl_b32 s39, s31, 7
    v_cmp_lt_u32 vcc, 7, v3
    v_add_u32 v15, -327616, v165
    v_add_u32 v174, 327744, v165
    v_cndmask_b32 v15, v165, v15, vcc
    v_cndmask_b32 v174, v174, v165, vcc
    s_lshl_b32 s45, s31, 5
    s_add_u32 s45, s45, 1024
    s_waitcnt vmcnt(10)
    v_add_f32 v8, v132, v134
    v_add_f32 v9, v136, v138
    s_nop 1
    v_permlane32_swap_b32 v8, v9
    v_add_f32 v8, v8, v9
    v_mov_b32 v9, v8
    s_nop 1
    v_permlane16_swap_b32 v8, v9
    v_add_f32 v8, v8, v9
    v_mov_b32 v9, v8
    s_nop 1
    v_permlane32_swap_b32 v8, v9
    v_mul_f32 v8, 0xbacccccd, v8
    v_mul_f32 v9, 0xbacccccd, v9
    v_cvt_pk_bf16_f32 v9, v8, v9
    v_lshlrev_b32 v8, 16, v9
    v_and_b32 v9, 0xffff0000, v9
    v_pk_mul_f32 v[44:45], v[16:17], v[8:9] op_sel:[0,0] op_sel_hi:[1,0]
    v_pk_mul_f32 v[46:47], v[18:19], v[8:9] op_sel:[0,0] op_sel_hi:[1,0]
    v_pk_mul_f32 v[48:49], v[16:17], v[8:9] op_sel:[0,1] op_sel_hi:[1,1]
    v_pk_mul_f32 v[50:51], v[18:19], v[8:9] op_sel:[0,1] op_sel_hi:[1,1]
    v_pk_mul_f32 v[52:53], v[20:21], v[8:9] op_sel:[0,0] op_sel_hi:[1,0]
    v_pk_mul_f32 v[54:55], v[22:23], v[8:9] op_sel:[0,0] op_sel_hi:[1,0]
    v_pk_mul_f32 v[56:57], v[20:21], v[8:9] op_sel:[0,1] op_sel_hi:[1,1]
    v_pk_mul_f32 v[58:59], v[22:23], v[8:9] op_sel:[0,1] op_sel_hi:[1,1]
    s_waitcnt vmcnt(8) lgkmcnt(10)
    v_mfma_f32_16x16x32_bf16 v[44:47], v[100:103], a[0:3], v[44:47]
    ds_read_b64_tr_b16 v[128:129], v168 offset:7168
    v_pk_mul_f32 v[60:61], v[24:25], v[8:9] op_sel:[0,0] op_sel_hi:[1,0]
    v_pk_mul_f32 v[62:63], v[26:27], v[8:9] op_sel:[0,0] op_sel_hi:[1,0]
    v_mfma_f32_16x16x32_bf16 v[48:51], v[100:103], a[4:7], v[48:51]
    ds_read_b64_tr_b16 v[130:131], v168 offset:8960
    v_pk_mul_f32 v[64:65], v[24:25], v[8:9] op_sel:[0,1] op_sel_hi:[1,1]
    v_pk_mul_f32 v[66:67], v[26:27], v[8:9] op_sel:[0,1] op_sel_hi:[1,1]
    v_mfma_f32_16x16x32_bf16 v[52:55], v[104:107], a[0:3], v[52:55]
    ds_read_b64_tr_b16 v[100:101], v168 offset:7200
    v_pk_mul_f32 v[68:69], v[28:29], v[8:9] op_sel:[0,0] op_sel_hi:[1,0]
    v_pk_mul_f32 v[70:71], v[30:31], v[8:9] op_sel:[0,0] op_sel_hi:[1,0]
    v_mfma_f32_16x16x32_bf16 v[56:59], v[104:107], a[4:7], v[56:59]
    ds_read_b64_tr_b16 v[102:103], v168 offset:8992
    v_pk_mul_f32 v[72:73], v[28:29], v[8:9] op_sel:[0,1] op_sel_hi:[1,1]
    v_pk_mul_f32 v[74:75], v[30:31], v[8:9] op_sel:[0,1] op_sel_hi:[1,1]
    s_waitcnt lgkmcnt(10)
    v_mfma_f32_16x16x32_bf16 v[60:63], v[108:111], a[0:3], v[60:63]
    ds_read_b64_tr_b16 v[104:105], v168 offset:7232
    v_pk_mul_f32 v[76:77], v[32:33], v[8:9] op_sel:[0,0] op_sel_hi:[1,0]
    v_pk_mul_f32 v[78:79], v[34:35], v[8:9] op_sel:[0,0] op_sel_hi:[1,0]
    v_mfma_f32_16x16x32_bf16 v[64:67], v[108:111], a[4:7], v[64:67]
    ds_read_b64_tr_b16 v[106:107], v168 offset:9024
    v_pk_mul_f32 v[80:81], v[32:33], v[8:9] op_sel:[0,1] op_sel_hi:[1,1]
    v_pk_mul_f32 v[82:83], v[34:35], v[8:9] op_sel:[0,1] op_sel_hi:[1,1]
    v_mfma_f32_16x16x32_bf16 v[68:71], v[112:115], a[0:3], v[68:71]
    ds_read_b64_tr_b16 v[108:109], v168 offset:7264
    v_pk_mul_f32 v[84:85], v[36:37], v[8:9] op_sel:[0,0] op_sel_hi:[1,0]
    v_pk_mul_f32 v[86:87], v[38:39], v[8:9] op_sel:[0,0] op_sel_hi:[1,0]
    v_mfma_f32_16x16x32_bf16 v[72:75], v[112:115], a[4:7], v[72:75]
    ds_read_b64_tr_b16 v[110:111], v168 offset:9056
    v_pk_mul_f32 v[88:89], v[36:37], v[8:9] op_sel:[0,1] op_sel_hi:[1,1]
    v_pk_mul_f32 v[90:91], v[38:39], v[8:9] op_sel:[0,1] op_sel_hi:[1,1]
    s_waitcnt lgkmcnt(10)
    v_mfma_f32_16x16x32_bf16 v[76:79], v[116:119], a[0:3], v[76:79]
    ds_read_b64_tr_b16 v[112:113], v168 offset:7296
    v_pk_mul_f32 v[92:93], v[40:41], v[8:9] op_sel:[0,0] op_sel_hi:[1,0]
    v_pk_mul_f32 v[94:95], v[42:43], v[8:9] op_sel:[0,0] op_sel_hi:[1,0]
    v_mfma_f32_16x16x32_bf16 v[80:83], v[116:119], a[4:7], v[80:83]
    ds_read_b64_tr_b16 v[114:115], v168 offset:9088
    v_pk_mul_f32 v[96:97], v[40:41], v[8:9] op_sel:[0,1] op_sel_hi:[1,1]
    v_pk_mul_f32 v[98:99], v[42:43], v[8:9] op_sel:[0,1] op_sel_hi:[1,1]
    v_mfma_f32_16x16x32_bf16 v[84:87], v[120:123], a[0:3], v[84:87]
    buffer_load_dwordx4 a[40:43], v4, s[8:11], s21 offen offset:1024 sc1
    v_mfma_f32_16x16x32_bf16 v[88:91], v[120:123], a[4:7], v[88:91]
    ds_read_b64_tr_b16 v[116:117], v168 offset:7328
    ds_read_b64_tr_b16 v[118:119], v168 offset:9120
    s_waitcnt lgkmcnt(10)
    v_mfma_f32_16x16x32_bf16 v[92:95], v[124:127], a[0:3], v[92:95]
    ds_read_b64_tr_b16 v[120:121], v171 offset:7168
    v_mfma_f32_16x16x32_bf16 v[96:99], v[124:127], a[4:7], v[96:99]
    ds_read_b64_tr_b16 v[122:123], v171 offset:8960
    s_waitcnt vmcnt(7)
    v_mfma_f32_16x16x32_bf16 v[44:47], v[128:131], a[8:11], v[44:47]
    buffer_load_dwordx4 a[44:47], v4, s[8:11], s22 offen offset:1024 sc1
    v_mfma_f32_16x16x32_bf16 v[48:51], v[128:131], a[12:15], v[48:51]
    ds_read_b64_tr_b16 v[124:125], v168 offset:14336
    ds_read_b64_tr_b16 v[126:127], v168 offset:16128
    s_waitcnt lgkmcnt(10)
    v_mfma_f32_16x16x32_bf16 v[52:55], v[100:103], a[8:11], v[52:55]
    ds_read_b64_tr_b16 v[128:129], v168 offset:14368
    v_mfma_f32_16x16x32_bf16 v[56:59], v[100:103], a[12:15], v[56:59]
    ds_read_b64_tr_b16 v[130:131], v168 offset:16160
    v_mfma_f32_16x16x32_bf16 v[60:63], v[104:107], a[8:11], v[60:63]
    buffer_load_dwordx4 a[48:51], v4, s[8:11], s21 offen offset:2048 sc1
    v_mfma_f32_16x16x32_bf16 v[64:67], v[104:107], a[12:15], v[64:67]
    ds_read_b64_tr_b16 v[100:101], v168 offset:14400
    ds_read_b64_tr_b16 v[102:103], v168 offset:16192
    s_waitcnt lgkmcnt(10)
    v_mfma_f32_16x16x32_bf16 v[68:71], v[108:111], a[8:11], v[68:71]
    ds_read_b64_tr_b16 v[104:105], v168 offset:14432
    v_mfma_f32_16x16x32_bf16 v[72:75], v[108:111], a[12:15], v[72:75]
    ds_read_b64_tr_b16 v[106:107], v168 offset:16224
    v_mfma_f32_16x16x32_bf16 v[76:79], v[112:115], a[8:11], v[76:79]
    buffer_load_dwordx4 a[52:55], v4, s[8:11], s22 offen offset:2048 sc1
    v_mfma_f32_16x16x32_bf16 v[80:83], v[112:115], a[12:15], v[80:83]
    ds_read_b64_tr_b16 v[108:109], v168 offset:21504
    ds_read_b64_tr_b16 v[110:111], v168 offset:23296
    s_waitcnt lgkmcnt(10)
    v_mfma_f32_16x16x32_bf16 v[84:87], v[116:119], a[8:11], v[84:87]
    ds_read_b64_tr_b16 v[112:113], v168 offset:21536
    v_mfma_f32_16x16x32_bf16 v[88:91], v[116:119], a[12:15], v[88:91]
    ds_read_b64_tr_b16 v[114:115], v168 offset:23328
    v_mfma_f32_16x16x32_bf16 v[92:95], v[120:123], a[8:11], v[92:95]
    s_add_u32 s62, s46, 20480
    buffer_load_dwordx4 v[176:179], v4, s[8:11], s62 offen offset:0 sc1
    v_mfma_f32_16x16x32_bf16 v[96:99], v[120:123], a[12:15], v[96:99]
    ds_read_b64_tr_b16 v[116:117], v168 offset:21568
    ds_read_b64_tr_b16 v[118:119], v168 offset:23360
    s_waitcnt vmcnt(9) lgkmcnt(10)
    v_mfma_f32_16x16x32_bf16 v[44:47], v[124:127], a[16:19], v[44:47]
    ds_read_b64_tr_b16 v[120:121], v168 offset:21600
    v_mfma_f32_16x16x32_bf16 v[48:51], v[124:127], a[20:23], v[48:51]
    ds_read_b64_tr_b16 v[122:123], v168 offset:23392
    v_mfma_f32_16x16x32_bf16 v[52:55], v[128:131], a[16:19], v[52:55]
    buffer_load_dwordx4 a[56:59], v4, s[8:11], s21 offen offset:3072 sc1
    s_add_u32 s21, s21, 4096
    v_mfma_f32_16x16x32_bf16 v[56:59], v[128:131], a[20:23], v[56:59]
    ds_read_b64_tr_b16 v[124:125], v168 offset:28672
    ds_read_b64_tr_b16 v[126:127], v168 offset:30464
    s_waitcnt lgkmcnt(10)
    v_mfma_f32_16x16x32_bf16 v[60:63], v[100:103], a[16:19], v[60:63]
    ds_read_b64_tr_b16 v[128:129], v168 offset:28704
    v_mfma_f32_16x16x32_bf16 v[64:67], v[100:103], a[20:23], v[64:67]
    ds_read_b64_tr_b16 v[130:131], v168 offset:30496
    v_mfma_f32_16x16x32_bf16 v[68:71], v[104:107], a[16:19], v[68:71]
    buffer_load_dwordx4 a[60:63], v4, s[8:11], s22 offen offset:3072 sc1
    s_add_u32 s22, s22, 4096
    v_mfma_f32_16x16x32_bf16 v[72:75], v[104:107], a[20:23], v[72:75]
    ds_read_b64_tr_b16 v[100:101], v168 offset:28736
    ds_read_b64_tr_b16 v[102:103], v168 offset:30528
    s_waitcnt vmcnt(9) lgkmcnt(10)
    v_mfma_f32_16x16x32_bf16 v[44:47], v[108:111], a[24:27], v[44:47]
    ds_read_b64_tr_b16 v[104:105], v168 offset:28768
    v_mfma_f32_16x16x32_bf16 v[48:51], v[108:111], a[28:31], v[48:51]
    ds_read_b64_tr_b16 v[106:107], v168 offset:30560
    v_mfma_f32_16x16x32_bf16 v[52:55], v[112:115], a[24:27], v[52:55]
    buffer_load_dwordx4 a[64:67], v4, s[8:11], s21 offen offset:0 sc1
    v_mfma_f32_16x16x32_bf16 v[56:59], v[112:115], a[28:31], v[56:59]
    ds_read_b64_tr_b16 v[108:109], v168 offset:35840
    ds_read_b64_tr_b16 v[110:111], v168 offset:37632
    s_waitcnt lgkmcnt(10)
    v_mfma_f32_16x16x32_bf16 v[60:63], v[116:119], a[24:27], v[60:63]
    ds_read_b64_tr_b16 v[112:113], v168 offset:35872
    v_mfma_f32_16x16x32_bf16 v[64:67], v[116:119], a[28:31], v[64:67]
    ds_read_b64_tr_b16 v[114:115], v168 offset:37664
    v_mfma_f32_16x16x32_bf16 v[68:71], v[120:123], a[24:27], v[68:71]
    buffer_load_dwordx4 a[68:71], v4, s[8:11], s22 offen offset:0 sc1
    v_mfma_f32_16x16x32_bf16 v[72:75], v[120:123], a[28:31], v[72:75]
    ds_read_b64_tr_b16 v[116:117], v168 offset:35904
    ds_read_b64_tr_b16 v[118:119], v168 offset:37696
    s_waitcnt vmcnt(9) lgkmcnt(10)
    v_mfma_f32_16x16x32_bf16 v[44:47], v[124:127], a[32:35], v[44:47]
    ds_read_b64_tr_b16 v[120:121], v168 offset:35936
    v_mfma_f32_16x16x32_bf16 v[48:51], v[124:127], a[36:39], v[48:51]
    ds_read_b64_tr_b16 v[122:123], v168 offset:37728
    v_mfma_f32_16x16x32_bf16 v[52:55], v[128:131], a[32:35], v[52:55]
    buffer_load_dwordx4 a[72:75], v4, s[8:11], s21 offen offset:1024 sc1
    v_mfma_f32_16x16x32_bf16 v[56:59], v[128:131], a[36:39], v[56:59]
    ds_read_b64_tr_b16 v[124:125], v168 offset:43008
    ds_read_b64_tr_b16 v[126:127], v168 offset:44800
    s_waitcnt lgkmcnt(10)
    v_mfma_f32_16x16x32_bf16 v[60:63], v[100:103], a[32:35], v[60:63]
    ds_read_b64_tr_b16 v[128:129], v168 offset:43040
    v_mfma_f32_16x16x32_bf16 v[64:67], v[100:103], a[36:39], v[64:67]
    ds_read_b64_tr_b16 v[130:131], v168 offset:44832
    v_mfma_f32_16x16x32_bf16 v[68:71], v[104:107], a[32:35], v[68:71]
    buffer_load_dwordx4 a[76:79], v4, s[8:11], s22 offen offset:1024 sc1
    v_mfma_f32_16x16x32_bf16 v[72:75], v[104:107], a[36:39], v[72:75]
    ds_read_b64_tr_b16 v[100:101], v168 offset:43072
    ds_read_b64_tr_b16 v[102:103], v168 offset:44864
    s_waitcnt vmcnt(9) lgkmcnt(10)
    v_mfma_f32_16x16x32_bf16 v[44:47], v[108:111], a[40:43], v[44:47]
    ds_read_b64_tr_b16 v[104:105], v168 offset:43104
    v_mfma_f32_16x16x32_bf16 v[48:51], v[108:111], a[44:47], v[48:51]
    ds_read_b64_tr_b16 v[106:107], v168 offset:44896
    v_mfma_f32_16x16x32_bf16 v[52:55], v[112:115], a[40:43], v[52:55]
    buffer_load_dwordx4 a[80:83], v4, s[8:11], s21 offen offset:2048 sc1
    v_mfma_f32_16x16x32_bf16 v[56:59], v[112:115], a[44:47], v[56:59]
    ds_read_b64_tr_b16 v[108:109], v168 offset:50176
    ds_read_b64_tr_b16 v[110:111], v168 offset:51968
    s_waitcnt lgkmcnt(10)
    v_mfma_f32_16x16x32_bf16 v[60:63], v[116:119], a[40:43], v[60:63]
    ds_read_b64_tr_b16 v[112:113], v168 offset:50208
    v_mfma_f32_16x16x32_bf16 v[64:67], v[116:119], a[44:47], v[64:67]
    ds_read_b64_tr_b16 v[114:115], v168 offset:52000
    v_mfma_f32_16x16x32_bf16 v[68:71], v[120:123], a[40:43], v[68:71]
    buffer_load_dwordx4 a[84:87], v4, s[8:11], s22 offen offset:2048 sc1
    v_mfma_f32_16x16x32_bf16 v[72:75], v[120:123], a[44:47], v[72:75]
    ds_read_b64_tr_b16 v[116:117], v168 offset:50240
    ds_read_b64_tr_b16 v[118:119], v168 offset:52032
    s_waitcnt vmcnt(9) lgkmcnt(10)
    v_mfma_f32_16x16x32_bf16 v[44:47], v[124:127], a[48:51], v[44:47]
    ds_read_b64_tr_b16 v[120:121], v168 offset:50272
    v_mfma_f32_16x16x32_bf16 v[48:51], v[124:127], a[52:55], v[48:51]
    ds_read_b64_tr_b16 v[122:123], v168 offset:52064
    v_mfma_f32_16x16x32_bf16 v[52:55], v[128:131], a[48:51], v[52:55]
    buffer_load_dwordx4 a[88:91], v4, s[8:11], s21 offen offset:3072 sc1
    s_add_u32 s21, s21, 4096
    v_mfma_f32_16x16x32_bf16 v[56:59], v[128:131], a[52:55], v[56:59]
    ds_read_b64_tr_b16 v[124:125], v169 offset:0
    ds_read_b64_tr_b16 v[126:127], v169 offset:1792
    s_waitcnt lgkmcnt(10)
    v_mfma_f32_16x16x32_bf16 v[60:63], v[100:103], a[48:51], v[60:63]
    ds_read_b64_tr_b16 v[128:129], v169 offset:32
    v_mfma_f32_16x16x32_bf16 v[64:67], v[100:103], a[52:55], v[64:67]
    ds_read_b64_tr_b16 v[130:131], v169 offset:1824
    v_mfma_f32_16x16x32_bf16 v[68:71], v[104:107], a[48:51], v[68:71]
    buffer_load_dwordx4 a[92:95], v4, s[8:11], s22 offen offset:3072 sc1
    s_add_u32 s22, s22, 4096
    v_mfma_f32_16x16x32_bf16 v[72:75], v[104:107], a[52:55], v[72:75]
    ds_read_b64_tr_b16 v[100:101], v169 offset:64
    ds_read_b64_tr_b16 v[102:103], v169 offset:1856
    s_waitcnt vmcnt(8) lgkmcnt(10)
    v_mfma_f32_16x16x32_bf16 v[44:47], v[108:111], a[56:59], v[44:47]
    ds_read_b64_tr_b16 v[104:105], v169 offset:96
    v_mfma_f32_16x16x32_bf16 v[48:51], v[108:111], a[60:63], v[48:51]
    ds_read_b64_tr_b16 v[106:107], v169 offset:1888
    v_mfma_f32_16x16x32_bf16 v[52:55], v[112:115], a[56:59], v[52:55]
    buffer_load_dwordx4 a[96:99], v4, s[8:11], s21 offen offset:0 sc1
    v_mfma_f32_16x16x32_bf16 v[56:59], v[112:115], a[60:63], v[56:59]
    ds_read_b64_tr_b16 v[108:109], v169 offset:7168
    ds_read_b64_tr_b16 v[110:111], v169 offset:8960
    s_waitcnt lgkmcnt(10)
    v_mfma_f32_16x16x32_bf16 v[60:63], v[116:119], a[56:59], v[60:63]
    ds_read_b64_tr_b16 v[112:113], v169 offset:7200
    v_mfma_f32_16x16x32_bf16 v[64:67], v[116:119], a[60:63], v[64:67]
    ds_read_b64_tr_b16 v[114:115], v169 offset:8992
    v_mfma_f32_16x16x32_bf16 v[68:71], v[120:123], a[56:59], v[68:71]
    buffer_load_dwordx4 a[100:103], v4, s[8:11], s22 offen offset:0 sc1
    v_mfma_f32_16x16x32_bf16 v[72:75], v[120:123], a[60:63], v[72:75]
    ds_read_b64_tr_b16 v[116:117], v169 offset:7232
    ds_read_b64_tr_b16 v[118:119], v169 offset:9024
    s_waitcnt vmcnt(8) lgkmcnt(10)
    v_mfma_f32_16x16x32_bf16 v[44:47], v[124:127], a[64:67], v[44:47]
    ds_read_b64_tr_b16 v[120:121], v169 offset:7264
    v_mfma_f32_16x16x32_bf16 v[48:51], v[124:127], a[68:71], v[48:51]
    ds_read_b64_tr_b16 v[122:123], v169 offset:9056
    v_mfma_f32_16x16x32_bf16 v[52:55], v[128:131], a[64:67], v[52:55]
    buffer_load_dwordx4 a[104:107], v4, s[8:11], s21 offen offset:1024 sc1
    v_mfma_f32_16x16x32_bf16 v[56:59], v[128:131], a[68:71], v[56:59]
    ds_read_b64_tr_b16 v[124:125], v169 offset:14336
    ds_read_b64_tr_b16 v[126:127], v169 offset:16128
    s_waitcnt lgkmcnt(10)
    v_mfma_f32_16x16x32_bf16 v[60:63], v[100:103], a[64:67], v[60:63]
    ds_read_b64_tr_b16 v[128:129], v169 offset:14368
    v_mfma_f32_16x16x32_bf16 v[64:67], v[100:103], a[68:71], v[64:67]
    ds_read_b64_tr_b16 v[130:131], v169 offset:16160
    v_mfma_f32_16x16x32_bf16 v[68:71], v[104:107], a[64:67], v[68:71]
    buffer_load_dwordx4 a[108:111], v4, s[8:11], s22 offen offset:1024 sc1
    v_mfma_f32_16x16x32_bf16 v[72:75], v[104:107], a[68:71], v[72:75]
    ds_read_b64_tr_b16 v[100:101], v169 offset:14400
    ds_read_b64_tr_b16 v[102:103], v169 offset:16192
    s_waitcnt vmcnt(8) lgkmcnt(10)
    v_mfma_f32_16x16x32_bf16 v[44:47], v[108:111], a[72:75], v[44:47]
    ds_read_b64_tr_b16 v[104:105], v169 offset:14432
    v_mfma_f32_16x16x32_bf16 v[48:51], v[108:111], a[76:79], v[48:51]
    ds_read_b64_tr_b16 v[106:107], v169 offset:16224
    v_mfma_f32_16x16x32_bf16 v[52:55], v[112:115], a[72:75], v[52:55]
    buffer_load_dwordx4 a[112:115], v4, s[8:11], s21 offen offset:2048 sc1
    v_mfma_f32_16x16x32_bf16 v[56:59], v[112:115], a[76:79], v[56:59]
    ds_read_b64_tr_b16 v[108:109], v169 offset:21504
    ds_read_b64_tr_b16 v[110:111], v169 offset:23296
    s_waitcnt lgkmcnt(10)
    v_mfma_f32_16x16x32_bf16 v[60:63], v[116:119], a[72:75], v[60:63]
    ds_read_b64_tr_b16 v[112:113], v169 offset:21536
    v_mfma_f32_16x16x32_bf16 v[64:67], v[116:119], a[76:79], v[64:67]
    ds_read_b64_tr_b16 v[114:115], v169 offset:23328
    v_mfma_f32_16x16x32_bf16 v[68:71], v[120:123], a[72:75], v[68:71]
    buffer_load_dwordx4 a[116:119], v4, s[8:11], s22 offen offset:2048 sc1
    v_mfma_f32_16x16x32_bf16 v[72:75], v[120:123], a[76:79], v[72:75]
    ds_read_b64_tr_b16 v[116:117], v169 offset:21568
    ds_read_b64_tr_b16 v[118:119], v169 offset:23360
    s_waitcnt vmcnt(8) lgkmcnt(10)
    v_mfma_f32_16x16x32_bf16 v[44:47], v[124:127], a[80:83], v[44:47]
    ds_read_b64_tr_b16 v[120:121], v169 offset:21600
    v_mfma_f32_16x16x32_bf16 v[48:51], v[124:127], a[84:87], v[48:51]
    ds_read_b64_tr_b16 v[122:123], v169 offset:23392
    v_mfma_f32_16x16x32_bf16 v[52:55], v[128:131], a[80:83], v[52:55]
    buffer_load_dwordx4 a[120:123], v4, s[8:11], s21 offen offset:3072 sc1
    s_add_u32 s21, s21, 4096
    v_mfma_f32_16x16x32_bf16 v[56:59], v[128:131], a[84:87], v[56:59]
    ds_read_b64_tr_b16 v[124:125], v169 offset:28672
    ds_read_b64_tr_b16 v[126:127], v169 offset:30464
    s_waitcnt lgkmcnt(10)
    v_mfma_f32_16x16x32_bf16 v[60:63], v[100:103], a[80:83], v[60:63]
    ds_read_b64_tr_b16 v[128:129], v169 offset:28704
    v_mfma_f32_16x16x32_bf16 v[64:67], v[100:103], a[84:87], v[64:67]
    ds_read_b64_tr_b16 v[130:131], v169 offset:30496
    v_mfma_f32_16x16x32_bf16 v[68:71], v[104:107], a[80:83], v[68:71]
    buffer_load_dwordx4 a[124:127], v4, s[8:11], s22 offen offset:3072 sc1
    s_add_u32 s22, s22, 4096
    v_mfma_f32_16x16x32_bf16 v[72:75], v[104:107], a[84:87], v[72:75]
    ds_read_b64_tr_b16 v[100:101], v169 offset:28736
    ds_read_b64_tr_b16 v[102:103], v169 offset:30528
    s_waitcnt vmcnt(8) lgkmcnt(10)
    v_mfma_f32_16x16x32_bf16 v[44:47], v[108:111], a[88:91], v[44:47]
    ds_read_b64_tr_b16 v[104:105], v169 offset:28768
    v_mfma_f32_16x16x32_bf16 v[48:51], v[108:111], a[92:95], v[48:51]
    ds_read_b64_tr_b16 v[106:107], v169 offset:30560
    v_mfma_f32_16x16x32_bf16 v[52:55], v[112:115], a[88:91], v[52:55]
    buffer_load_dwordx4 a[128:131], v4, s[8:11], s21 offen offset:0 sc1
    v_mfma_f32_16x16x32_bf16 v[56:59], v[112:115], a[92:95], v[56:59]
    ds_read_b64_tr_b16 v[108:109], v169 offset:35840
    ds_read_b64_tr_b16 v[110:111], v169 offset:37632
    s_waitcnt lgkmcnt(10)
    v_mfma_f32_16x16x32_bf16 v[60:63], v[116:119], a[88:91], v[60:63]
    ds_read_b64_tr_b16 v[112:113], v169 offset:35872
    v_mfma_f32_16x16x32_bf16 v[64:67], v[116:119], a[92:95], v[64:67]
    ds_read_b64_tr_b16 v[114:115], v169 offset:37664
    v_mfma_f32_16x16x32_bf16 v[68:71], v[120:123], a[88:91], v[68:71]
    buffer_load_dwordx4 a[132:135], v4, s[8:11], s22 offen offset:0 sc1
    v_mfma_f32_16x16x32_bf16 v[72:75], v[120:123], a[92:95], v[72:75]
    ds_read_b64_tr_b16 v[116:117], v169 offset:35904
    ds_read_b64_tr_b16 v[118:119], v169 offset:37696
    s_waitcnt vmcnt(8) lgkmcnt(10)
    v_mfma_f32_16x16x32_bf16 v[44:47], v[124:127], a[96:99], v[44:47]
    ds_read_b64_tr_b16 v[120:121], v169 offset:35936
    v_mfma_f32_16x16x32_bf16 v[48:51], v[124:127], a[100:103], v[48:51]
    ds_read_b64_tr_b16 v[122:123], v169 offset:37728
    v_mfma_f32_16x16x32_bf16 v[52:55], v[128:131], a[96:99], v[52:55]
    buffer_load_dwordx4 a[136:139], v4, s[8:11], s21 offen offset:1024 sc1
    v_mfma_f32_16x16x32_bf16 v[56:59], v[128:131], a[100:103], v[56:59]
    ds_read_b64_tr_b16 v[124:125], v169 offset:43008
    ds_read_b64_tr_b16 v[126:127], v169 offset:44800
    s_waitcnt lgkmcnt(10)
    v_mfma_f32_16x16x32_bf16 v[60:63], v[100:103], a[96:99], v[60:63]
    ds_read_b64_tr_b16 v[128:129], v169 offset:43040
    v_mfma_f32_16x16x32_bf16 v[64:67], v[100:103], a[100:103], v[64:67]
    ds_read_b64_tr_b16 v[130:131], v169 offset:44832
    v_mfma_f32_16x16x32_bf16 v[68:71], v[104:107], a[96:99], v[68:71]
    buffer_load_dwordx4 a[140:143], v4, s[8:11], s22 offen offset:1024 sc1
    v_mfma_f32_16x16x32_bf16 v[72:75], v[104:107], a[100:103], v[72:75]
    ds_read_b64_tr_b16 v[100:101], v169 offset:43072
    ds_read_b64_tr_b16 v[102:103], v169 offset:44864
    s_waitcnt vmcnt(8) lgkmcnt(10)
    v_mfma_f32_16x16x32_bf16 v[44:47], v[108:111], a[104:107], v[44:47]
    ds_read_b64_tr_b16 v[104:105], v169 offset:43104
    v_mfma_f32_16x16x32_bf16 v[48:51], v[108:111], a[108:111], v[48:51]
    ds_read_b64_tr_b16 v[106:107], v169 offset:44896
    v_mfma_f32_16x16x32_bf16 v[52:55], v[112:115], a[104:107], v[52:55]
    buffer_load_dwordx4 a[0:3], v4, s[8:11], s21 offen offset:2048 sc1
    v_mfma_f32_16x16x32_bf16 v[56:59], v[112:115], a[108:111], v[56:59]
    ds_read_b64_tr_b16 v[108:109], v169 offset:50176
    ds_read_b64_tr_b16 v[110:111], v169 offset:51968
    s_waitcnt lgkmcnt(10)
    v_mfma_f32_16x16x32_bf16 v[60:63], v[116:119], a[104:107], v[60:63]
    ds_read_b64_tr_b16 v[112:113], v169 offset:50208
    v_mfma_f32_16x16x32_bf16 v[64:67], v[116:119], a[108:111], v[64:67]
    ds_read_b64_tr_b16 v[114:115], v169 offset:52000
    v_mfma_f32_16x16x32_bf16 v[68:71], v[120:123], a[104:107], v[68:71]
    buffer_load_dwordx4 a[4:7], v4, s[8:11], s22 offen offset:2048 sc1
    v_mfma_f32_16x16x32_bf16 v[72:75], v[120:123], a[108:111], v[72:75]
    ds_read_b64_tr_b16 v[116:117], v169 offset:50240
    ds_read_b64_tr_b16 v[118:119], v169 offset:52032
    s_waitcnt vmcnt(8) lgkmcnt(10)
    v_mfma_f32_16x16x32_bf16 v[44:47], v[124:127], a[112:115], v[44:47]
    ds_read_b64_tr_b16 v[120:121], v169 offset:50272
    v_mfma_f32_16x16x32_bf16 v[48:51], v[124:127], a[116:119], v[48:51]
    ds_read_b64_tr_b16 v[122:123], v169 offset:52064
    v_mfma_f32_16x16x32_bf16 v[52:55], v[128:131], a[112:115], v[52:55]
    buffer_load_dwordx4 a[8:11], v4, s[8:11], s21 offen offset:3072 sc1
    s_add_u32 s21, s21, 4096
    v_mfma_f32_16x16x32_bf16 v[56:59], v[128:131], a[116:119], v[56:59]
    ds_read_b64_tr_b16 v[124:125], v170 offset:0
    ds_read_b64_tr_b16 v[126:127], v170 offset:1792
    s_waitcnt lgkmcnt(10)
    v_mfma_f32_16x16x32_bf16 v[60:63], v[100:103], a[112:115], v[60:63]
    ds_read_b64_tr_b16 v[128:129], v170 offset:32
    v_mfma_f32_16x16x32_bf16 v[64:67], v[100:103], a[116:119], v[64:67]
    ds_read_b64_tr_b16 v[130:131], v170 offset:1824
    v_mfma_f32_16x16x32_bf16 v[68:71], v[104:107], a[112:115], v[68:71]
    buffer_load_dwordx4 a[12:15], v4, s[8:11], s22 offen offset:3072 sc1
    s_add_u32 s22, s22, 4096
    v_mfma_f32_16x16x32_bf16 v[72:75], v[104:107], a[116:119], v[72:75]
    ds_read_b64_tr_b16 v[100:101], v170 offset:64
    ds_read_b64_tr_b16 v[102:103], v170 offset:1856
    s_waitcnt vmcnt(8) lgkmcnt(10)
    v_mfma_f32_16x16x32_bf16 v[44:47], v[108:111], a[120:123], v[44:47]
    ds_read_b64_tr_b16 v[104:105], v170 offset:96
    v_mfma_f32_16x16x32_bf16 v[48:51], v[108:111], a[124:127], v[48:51]
    ds_read_b64_tr_b16 v[106:107], v170 offset:1888
    v_mfma_f32_16x16x32_bf16 v[52:55], v[112:115], a[120:123], v[52:55]
    buffer_load_dwordx4 v[180:183], v4, s[8:11], s62 offen offset:1024 sc1
    v_mfma_f32_16x16x32_bf16 v[56:59], v[112:115], a[124:127], v[56:59]
    ds_read_b64_tr_b16 v[108:109], v170 offset:7168
    ds_read_b64_tr_b16 v[110:111], v170 offset:8960
    s_waitcnt lgkmcnt(10)
    v_mfma_f32_16x16x32_bf16 v[60:63], v[116:119], a[120:123], v[60:63]
    ds_read_b64_tr_b16 v[112:113], v170 offset:7200
    v_mfma_f32_16x16x32_bf16 v[64:67], v[116:119], a[124:127], v[64:67]
    ds_read_b64_tr_b16 v[114:115], v170 offset:8992
    v_mfma_f32_16x16x32_bf16 v[68:71], v[120:123], a[120:123], v[68:71]
    buffer_load_dwordx4 v[184:187], v4, s[8:11], s62 offen offset:2048 sc1
    v_mfma_f32_16x16x32_bf16 v[72:75], v[120:123], a[124:127], v[72:75]
    ds_read_b64_tr_b16 v[116:117], v170 offset:7232
    ds_read_b64_tr_b16 v[118:119], v170 offset:9024
    s_waitcnt vmcnt(8) lgkmcnt(10)
    v_mfma_f32_16x16x32_bf16 v[44:47], v[124:127], a[128:131], v[44:47]
    ds_read_b64_tr_b16 v[120:121], v170 offset:7264
    v_mfma_f32_16x16x32_bf16 v[48:51], v[124:127], a[132:135], v[48:51]
    ds_read_b64_tr_b16 v[122:123], v170 offset:9056
    v_mfma_f32_16x16x32_bf16 v[52:55], v[128:131], a[128:131], v[52:55]
    buffer_load_dwordx4 v[188:191], v4, s[8:11], s62 offen offset:3072 sc1
    v_mfma_f32_16x16x32_bf16 v[56:59], v[128:131], a[132:135], v[56:59]
    ds_read_b64_tr_b16 v[124:125], v170 offset:14336
    ds_read_b64_tr_b16 v[126:127], v170 offset:16128
    s_waitcnt lgkmcnt(10)
    v_mfma_f32_16x16x32_bf16 v[60:63], v[100:103], a[128:131], v[60:63]
    ds_read_b64_tr_b16 v[128:129], v170 offset:14368
    v_mfma_f32_16x16x32_bf16 v[64:67], v[100:103], a[132:135], v[64:67]
    ds_read_b64_tr_b16 v[130:131], v170 offset:16160
    v_mfma_f32_16x16x32_bf16 v[68:71], v[104:107], a[128:131], v[68:71]
    s_add_u32 s62, s62, 4096
    buffer_load_dwordx4 v[192:195], v4, s[8:11], s62 offen offset:0 sc1
    v_mfma_f32_16x16x32_bf16 v[72:75], v[104:107], a[132:135], v[72:75]
    ds_read_b64_tr_b16 v[100:101], v170 offset:14400
    ds_read_b64_tr_b16 v[102:103], v170 offset:16192
    s_waitcnt vmcnt(8) lgkmcnt(10)
    v_mfma_f32_16x16x32_bf16 v[44:47], v[108:111], a[136:139], v[44:47]
    ds_read_b64_tr_b16 v[104:105], v170 offset:14432
    v_mfma_f32_16x16x32_bf16 v[48:51], v[108:111], a[140:143], v[48:51]
    ds_read_b64_tr_b16 v[106:107], v170 offset:16224
    v_mfma_f32_16x16x32_bf16 v[52:55], v[112:115], a[136:139], v[52:55]
    s_add_u32 s62, s46, 25600
    buffer_load_dwordx4 v[196:199], v4, s[8:11], s62 offen offset:0 sc1
    v_mfma_f32_16x16x32_bf16 v[56:59], v[112:115], a[140:143], v[56:59]
    ds_read_b64_tr_b16 v[108:109], v170 offset:21504
    ds_read_b64_tr_b16 v[110:111], v170 offset:23296
    s_waitcnt lgkmcnt(10)
    v_mfma_f32_16x16x32_bf16 v[60:63], v[116:119], a[136:139], v[60:63]
    ds_read_b64_tr_b16 v[112:113], v170 offset:21536
    v_mfma_f32_16x16x32_bf16 v[64:67], v[116:119], a[140:143], v[64:67]
    ds_read_b64_tr_b16 v[114:115], v170 offset:23328
    v_mfma_f32_16x16x32_bf16 v[68:71], v[120:123], a[136:139], v[68:71]
    buffer_load_dwordx4 v[200:203], v4, s[8:11], s62 offen offset:1024 sc1
    v_mfma_f32_16x16x32_bf16 v[72:75], v[120:123], a[140:143], v[72:75]
    ds_read_b64_tr_b16 v[116:117], v170 offset:21568
    ds_read_b64_tr_b16 v[118:119], v170 offset:23360
    s_waitcnt vmcnt(8) lgkmcnt(10)
    v_mfma_f32_16x16x32_bf16 v[44:47], v[124:127], a[0:3], v[44:47]
    ds_read_b64_tr_b16 v[120:121], v170 offset:21600
    v_mfma_f32_16x16x32_bf16 v[48:51], v[124:127], a[4:7], v[48:51]
    ds_read_b64_tr_b16 v[122:123], v170 offset:23392
    v_mfma_f32_16x16x32_bf16 v[52:55], v[128:131], a[0:3], v[52:55]
    buffer_load_dwordx4 v[204:207], v4, s[8:11], s62 offen offset:2048 sc1
    v_mfma_f32_16x16x32_bf16 v[56:59], v[128:131], a[4:7], v[56:59]
    ds_read_b64_tr_b16 v[124:125], v168 offset:14464
    ds_read_b64_tr_b16 v[126:127], v168 offset:16256
    s_waitcnt lgkmcnt(10)
    v_mfma_f32_16x16x32_bf16 v[60:63], v[100:103], a[0:3], v[60:63]
    ds_read_b64_tr_b16 v[128:129], v168 offset:14496
    v_mfma_f32_16x16x32_bf16 v[64:67], v[100:103], a[4:7], v[64:67]
    ds_read_b64_tr_b16 v[130:131], v168 offset:16288
    v_mfma_f32_16x16x32_bf16 v[68:71], v[104:107], a[0:3], v[68:71]
    buffer_load_dwordx4 v[208:211], v4, s[8:11], s62 offen offset:3072 sc1
    v_mfma_f32_16x16x32_bf16 v[72:75], v[104:107], a[4:7], v[72:75]
    ds_read_b64_tr_b16 v[100:101], v171 offset:14336
    ds_read_b64_tr_b16 v[102:103], v171 offset:16128
    s_waitcnt vmcnt(8) lgkmcnt(10)
    v_mfma_f32_16x16x32_bf16 v[44:47], v[108:111], a[8:11], v[44:47]
    ds_read_b64_tr_b16 v[104:105], v168 offset:21632
    v_mfma_f32_16x16x32_bf16 v[48:51], v[108:111], a[12:15], v[48:51]
    ds_read_b64_tr_b16 v[106:107], v168 offset:23424
    v_mfma_f32_16x16x32_bf16 v[52:55], v[112:115], a[8:11], v[52:55]
    ds_read_b64_tr_b16 v[108:109], v168 offset:21664
    v_mfma_f32_16x16x32_bf16 v[56:59], v[112:115], a[12:15], v[56:59]
    ds_read_b64_tr_b16 v[110:111], v168 offset:23456
    s_waitcnt lgkmcnt(10)
    v_mfma_f32_16x16x32_bf16 v[60:63], v[116:119], a[8:11], v[60:63]
    ds_read_b64_tr_b16 v[112:113], v171 offset:21504
    v_mfma_f32_16x16x32_bf16 v[64:67], v[116:119], a[12:15], v[64:67]
    ds_read_b64_tr_b16 v[114:115], v171 offset:23296
    v_mfma_f32_16x16x32_bf16 v[68:71], v[120:123], a[8:11], v[68:71]
    ds_read_b64_tr_b16 v[116:117], v168 offset:28800
    v_mfma_f32_16x16x32_bf16 v[72:75], v[120:123], a[12:15], v[72:75]
    ds_read_b64_tr_b16 v[118:119], v168 offset:30592
    s_waitcnt lgkmcnt(10)
    v_mfma_f32_16x16x32_bf16 v[76:79], v[124:127], a[16:19], v[76:79]
    ds_read_b64_tr_b16 v[120:121], v168 offset:28832
    v_mfma_f32_16x16x32_bf16 v[80:83], v[124:127], a[20:23], v[80:83]
    ds_read_b64_tr_b16 v[122:123], v168 offset:30624
    v_mfma_f32_16x16x32_bf16 v[84:87], v[128:131], a[16:19], v[84:87]
    ds_read_b64_tr_b16 v[124:125], v171 offset:28672
    v_cvt_pk_bf16_f32 v140, v44, v45
    v_cvt_pk_bf16_f32 v141, v46, v47
    v_cvt_pk_bf16_f32 v142, v52, v53
    v_cvt_pk_bf16_f32 v143, v54, v55
    v_pk_max_i16 v140, v140, 0
    v_pk_max_i16 v141, v141, 0
    v_pk_max_i16 v142, v142, 0
    v_pk_max_i16 v143, v143, 0
    buffer_store_dwordx4 v[140:143], v4, s[8:11], s12 offen sc1
    v_cvt_pk_bf16_f32 v144, v48, v49
    v_cvt_pk_bf16_f32 v145, v50, v51
    v_cvt_pk_bf16_f32 v146, v56, v57
    v_cvt_pk_bf16_f32 v147, v58, v59
    v_pk_max_i16 v144, v144, 0
    v_pk_max_i16 v145, v145, 0
    v_pk_max_i16 v146, v146, 0
    v_pk_max_i16 v147, v147, 0
    s_add_u32 s12, s12, 57344
    buffer_store_dwordx4 v[144:147], v4, s[8:11], s12 offen sc1
    v_cvt_pk_bf16_f32 v148, v60, v61
    v_cvt_pk_bf16_f32 v149, v62, v63
    v_cvt_pk_bf16_f32 v150, v68, v69
    v_cvt_pk_bf16_f32 v151, v70, v71
    v_pk_max_i16 v148, v148, 0
    v_pk_max_i16 v149, v149, 0
    v_pk_max_i16 v150, v150, 0
    v_pk_max_i16 v151, v151, 0
    buffer_store_dwordx4 v[148:151], v4, s[8:11], s13 offen sc1
    v_cvt_pk_bf16_f32 v152, v64, v65
    v_cvt_pk_bf16_f32 v153, v66, v67
    v_cvt_pk_bf16_f32 v154, v72, v73
    v_cvt_pk_bf16_f32 v155, v74, v75
    v_pk_max_i16 v152, v152, 0
    v_pk_max_i16 v153, v153, 0
    v_pk_max_i16 v154, v154, 0
    v_pk_max_i16 v155, v155, 0
    s_add_u32 s13, s13, 57344
    buffer_store_dwordx4 v[152:155], v4, s[8:11], s13 offen sc1
    v_mfma_f32_16x16x32_bf16 v[88:91], v[128:131], a[20:23], v[88:91]
    ds_read_b64_tr_b16 v[126:127], v171 offset:30464
    s_waitcnt lgkmcnt(10)
    v_mfma_f32_16x16x32_bf16 v[92:95], v[100:103], a[16:19], v[92:95]
    ds_read_b64_tr_b16 v[128:129], v168 offset:35968
    v_mfma_f32_16x16x32_bf16 v[96:99], v[100:103], a[20:23], v[96:99]
    ds_read_b64_tr_b16 v[130:131], v168 offset:37760
    v_mfma_f32_16x16x32_bf16 v[76:79], v[104:107], a[24:27], v[76:79]
    s_add_u32 s62, s62, 4096
    buffer_load_dwordx4 v[212:215], v4, s[8:11], s62 offen offset:0 sc1
    v_mfma_f32_16x16x32_bf16 v[80:83], v[104:107], a[28:31], v[80:83]
    ds_read_b64_tr_b16 v[100:101], v168 offset:36000
    ds_read_b64_tr_b16 v[102:103], v168 offset:37792
    s_waitcnt lgkmcnt(10)
    v_mfma_f32_16x16x32_bf16 v[84:87], v[108:111], a[24:27], v[84:87]
    ds_read_b64_tr_b16 v[104:105], v171 offset:35840
    v_mfma_f32_16x16x32_bf16 v[88:91], v[108:111], a[28:31], v[88:91]
    ds_read_b64_tr_b16 v[106:107], v171 offset:37632
    v_mfma_f32_16x16x32_bf16 v[92:95], v[112:115], a[24:27], v[92:95]
    s_add_u32 s62, s46, 30720
    buffer_load_dwordx4 v[216:219], v4, s[8:11], s62 offen offset:0 sc1
    v_mfma_f32_16x16x32_bf16 v[96:99], v[112:115], a[28:31], v[96:99]
    ds_read_b64_tr_b16 v[108:109], v168 offset:43136
    ds_read_b64_tr_b16 v[110:111], v168 offset:44928
    s_waitcnt lgkmcnt(10)
    v_mfma_f32_16x16x32_bf16 v[76:79], v[116:119], a[32:35], v[76:79]
    ds_read_b64_tr_b16 v[112:113], v168 offset:43168
    v_mfma_f32_16x16x32_bf16 v[80:83], v[116:119], a[36:39], v[80:83]
    ds_read_b64_tr_b16 v[114:115], v168 offset:44960
    v_mfma_f32_16x16x32_bf16 v[84:87], v[120:123], a[32:35], v[84:87]
    buffer_load_dwordx4 v[220:223], v4, s[8:11], s62 offen offset:1024 sc1
    v_mfma_f32_16x16x32_bf16 v[88:91], v[120:123], a[36:39], v[88:91]
    ds_read_b64_tr_b16 v[116:117], v171 offset:43008
    ds_read_b64_tr_b16 v[118:119], v171 offset:44800
    s_waitcnt lgkmcnt(10)
    v_mfma_f32_16x16x32_bf16 v[92:95], v[124:127], a[32:35], v[92:95]
    ds_read_b64_tr_b16 v[120:121], v168 offset:50304
    v_mfma_f32_16x16x32_bf16 v[96:99], v[124:127], a[36:39], v[96:99]
    ds_read_b64_tr_b16 v[122:123], v168 offset:52096
    v_mfma_f32_16x16x32_bf16 v[76:79], v[128:131], a[40:43], v[76:79]
    buffer_load_dwordx4 v[224:227], v4, s[8:11], s62 offen offset:2048 sc1
    v_mfma_f32_16x16x32_bf16 v[80:83], v[128:131], a[44:47], v[80:83]
    ds_read_b64_tr_b16 v[124:125], v168 offset:50336
    ds_read_b64_tr_b16 v[126:127], v168 offset:52128
    s_waitcnt lgkmcnt(10)
    v_mfma_f32_16x16x32_bf16 v[84:87], v[100:103], a[40:43], v[84:87]
    ds_read_b64_tr_b16 v[128:129], v171 offset:50176
    v_mfma_f32_16x16x32_bf16 v[88:91], v[100:103], a[44:47], v[88:91]
    ds_read_b64_tr_b16 v[130:131], v171 offset:51968
    v_mfma_f32_16x16x32_bf16 v[92:95], v[104:107], a[40:43], v[92:95]
    buffer_load_dwordx4 v[228:231], v4, s[8:11], s62 offen offset:3072 sc1
    v_mfma_f32_16x16x32_bf16 v[96:99], v[104:107], a[44:47], v[96:99]
    ds_read_b64_tr_b16 v[100:101], v169 offset:128
    ds_read_b64_tr_b16 v[102:103], v169 offset:1920
    s_waitcnt lgkmcnt(10)
    v_mfma_f32_16x16x32_bf16 v[76:79], v[108:111], a[48:51], v[76:79]
    ds_read_b64_tr_b16 v[104:105], v169 offset:160
    v_mfma_f32_16x16x32_bf16 v[80:83], v[108:111], a[52:55], v[80:83]
    ds_read_b64_tr_b16 v[106:107], v169 offset:1952
    v_mfma_f32_16x16x32_bf16 v[84:87], v[112:115], a[48:51], v[84:87]
    s_add_u32 s62, s62, 4096
    buffer_load_dwordx4 v[232:235], v4, s[8:11], s62 offen offset:0 sc1
    v_mfma_f32_16x16x32_bf16 v[88:91], v[112:115], a[52:55], v[88:91]
    ds_read_b64_tr_b16 v[108:109], v172 offset:0
    ds_read_b64_tr_b16 v[110:111], v172 offset:1792
    s_waitcnt lgkmcnt(10)
    v_mfma_f32_16x16x32_bf16 v[92:95], v[116:119], a[48:51], v[92:95]
    ds_read_b64_tr_b16 v[112:113], v169 offset:7296
    v_mfma_f32_16x16x32_bf16 v[96:99], v[116:119], a[52:55], v[96:99]
    ds_read_b64_tr_b16 v[114:115], v169 offset:9088
    v_mfma_f32_16x16x32_bf16 v[76:79], v[120:123], a[56:59], v[76:79]
    s_add_u32 s62, s46, 35840
    buffer_load_dwordx4 v[236:239], v4, s[8:11], s62 offen offset:0 sc1
    v_mfma_f32_16x16x32_bf16 v[80:83], v[120:123], a[60:63], v[80:83]
    ds_read_b64_tr_b16 v[116:117], v169 offset:7328
    ds_read_b64_tr_b16 v[118:119], v169 offset:9120
    s_waitcnt lgkmcnt(10)
    v_mfma_f32_16x16x32_bf16 v[84:87], v[124:127], a[56:59], v[84:87]
    ds_read_b64_tr_b16 v[120:121], v172 offset:7168
    v_mfma_f32_16x16x32_bf16 v[88:91], v[124:127], a[60:63], v[88:91]
    ds_read_b64_tr_b16 v[122:123], v172 offset:8960
    v_mfma_f32_16x16x32_bf16 v[92:95], v[128:131], a[56:59], v[92:95]
    buffer_load_dwordx4 v[240:243], v4, s[8:11], s62 offen offset:1024 sc1
    v_mfma_f32_16x16x32_bf16 v[96:99], v[128:131], a[60:63], v[96:99]
    ds_read_b64_tr_b16 v[124:125], v169 offset:14464
    ds_read_b64_tr_b16 v[126:127], v169 offset:16256
    s_waitcnt lgkmcnt(10)
    v_mfma_f32_16x16x32_bf16 v[76:79], v[100:103], a[64:67], v[76:79]
    ds_read_b64_tr_b16 v[128:129], v169 offset:14496
    v_mfma_f32_16x16x32_bf16 v[80:83], v[100:103], a[68:71], v[80:83]
    ds_read_b64_tr_b16 v[130:131], v169 offset:16288
    v_mfma_f32_16x16x32_bf16 v[84:87], v[104:107], a[64:67], v[84:87]
    buffer_load_dwordx4 v[244:247], v4, s[8:11], s62 offen offset:2048 sc1
    v_mfma_f32_16x16x32_bf16 v[88:91], v[104:107], a[68:71], v[88:91]
    ds_read_b64_tr_b16 v[100:101], v172 offset:14336
    ds_read_b64_tr_b16 v[102:103], v172 offset:16128
    s_waitcnt lgkmcnt(10)
    v_mfma_f32_16x16x32_bf16 v[92:95], v[108:111], a[64:67], v[92:95]
    ds_read_b64_tr_b16 v[104:105], v169 offset:21632
    v_mfma_f32_16x16x32_bf16 v[96:99], v[108:111], a[68:71], v[96:99]
    ds_read_b64_tr_b16 v[106:107], v169 offset:23424
    v_mfma_f32_16x16x32_bf16 v[76:79], v[112:115], a[72:75], v[76:79]
    buffer_load_dwordx4 v[248:251], v4, s[8:11], s62 offen offset:3072 sc1
    v_mfma_f32_16x16x32_bf16 v[80:83], v[112:115], a[76:79], v[80:83]
    ds_read_b64_tr_b16 v[108:109], v169 offset:21664
    ds_read_b64_tr_b16 v[110:111], v169 offset:23456
    s_waitcnt vmcnt(10)
    v_mov_b32 v6, s48
    s_mov_b64 exec, 1
    buffer_atomic_add v5, v6, s[8:11], 0 offen sc1
    s_mov_b64 exec, -1
    s_waitcnt lgkmcnt(10)
    v_mfma_f32_16x16x32_bf16 v[84:87], v[116:119], a[72:75], v[84:87]
    ds_read_b64_tr_b16 v[112:113], v172 offset:21504
    v_mfma_f32_16x16x32_bf16 v[88:91], v[116:119], a[76:79], v[88:91]
    ds_read_b64_tr_b16 v[114:115], v172 offset:23296
    v_mfma_f32_16x16x32_bf16 v[92:95], v[120:123], a[72:75], v[92:95]
    s_add_u32 s62, s62, 4096
    buffer_load_dwordx4 v[252:255], v4, s[8:11], s62 offen offset:0 sc1
    v_mfma_f32_16x16x32_bf16 v[96:99], v[120:123], a[76:79], v[96:99]
    ds_read_b64_tr_b16 v[116:117], v169 offset:28800
    ds_read_b64_tr_b16 v[118:119], v169 offset:30592
    s_waitcnt lgkmcnt(10)
    v_mfma_f32_16x16x32_bf16 v[76:79], v[124:127], a[80:83], v[76:79]
    ds_read_b64_tr_b16 v[120:121], v169 offset:28832
    v_mfma_f32_16x16x32_bf16 v[80:83], v[124:127], a[84:87], v[80:83]
    ds_read_b64_tr_b16 v[122:123], v169 offset:30624
    v_mfma_f32_16x16x32_bf16 v[84:87], v[128:131], a[80:83], v[84:87]
    s_add_u32 s62, s46, 40960
    buffer_load_dwordx4 a[144:147], v10, s[8:11], s62 offen offset:0 sc1
    v_mfma_f32_16x16x32_bf16 v[88:91], v[128:131], a[84:87], v[88:91]
    ds_read_b64_tr_b16 v[124:125], v172 offset:28672
    ds_read_b64_tr_b16 v[126:127], v172 offset:30464
    s_waitcnt lgkmcnt(10)
    v_mfma_f32_16x16x32_bf16 v[92:95], v[100:103], a[80:83], v[92:95]
    ds_read_b64_tr_b16 v[128:129], v169 offset:35968
    v_mfma_f32_16x16x32_bf16 v[96:99], v[100:103], a[84:87], v[96:99]
    ds_read_b64_tr_b16 v[130:131], v169 offset:37760
    v_mfma_f32_16x16x32_bf16 v[76:79], v[104:107], a[88:91], v[76:79]
    buffer_load_dwordx4 a[148:151], v10, s[8:11], s62 offen offset:1024 sc1
    v_mfma_f32_16x16x32_bf16 v[80:83], v[104:107], a[92:95], v[80:83]
    ds_read_b64_tr_b16 v[100:101], v169 offset:36000
    ds_read_b64_tr_b16 v[102:103], v169 offset:37792
    s_waitcnt lgkmcnt(10)
    v_mfma_f32_16x16x32_bf16 v[84:87], v[108:111], a[88:91], v[84:87]
    ds_read_b64_tr_b16 v[104:105], v172 offset:35840
    v_mfma_f32_16x16x32_bf16 v[88:91], v[108:111], a[92:95], v[88:91]
    ds_read_b64_tr_b16 v[106:107], v172 offset:37632
    v_mfma_f32_16x16x32_bf16 v[92:95], v[112:115], a[88:91], v[92:95]
    buffer_load_dwordx4 a[152:155], v10, s[8:11], s62 offen offset:2048 sc1
    v_mfma_f32_16x16x32_bf16 v[96:99], v[112:115], a[92:95], v[96:99]
    ds_read_b64_tr_b16 v[108:109], v169 offset:43136
    ds_read_b64_tr_b16 v[110:111], v169 offset:44928
    s_waitcnt lgkmcnt(10)
    v_mfma_f32_16x16x32_bf16 v[76:79], v[116:119], a[96:99], v[76:79]
    ds_read_b64_tr_b16 v[112:113], v169 offset:43168
    v_mfma_f32_16x16x32_bf16 v[80:83], v[116:119], a[100:103], v[80:83]
    ds_read_b64_tr_b16 v[114:115], v169 offset:44960
    v_mfma_f32_16x16x32_bf16 v[84:87], v[120:123], a[96:99], v[84:87]
    buffer_load_dwordx4 a[156:159], v10, s[8:11], s62 offen offset:3072 sc1
    v_mfma_f32_16x16x32_bf16 v[88:91], v[120:123], a[100:103], v[88:91]
    ds_read_b64_tr_b16 v[116:117], v172 offset:43008
    ds_read_b64_tr_b16 v[118:119], v172 offset:44800
    s_waitcnt lgkmcnt(10)
    v_mfma_f32_16x16x32_bf16 v[92:95], v[124:127], a[96:99], v[92:95]
    ds_read_b64_tr_b16 v[120:121], v169 offset:50304
    v_mfma_f32_16x16x32_bf16 v[96:99], v[124:127], a[100:103], v[96:99]
    ds_read_b64_tr_b16 v[122:123], v169 offset:52096
    v_mfma_f32_16x16x32_bf16 v[76:79], v[128:131], a[104:107], v[76:79]
    s_add_u32 s62, s62, 4096
    buffer_load_dwordx4 a[48:51], v10, s[8:11], s62 offen offset:0 sc1
    v_mfma_f32_16x16x32_bf16 v[80:83], v[128:131], a[108:111], v[80:83]
    ds_read_b64_tr_b16 v[124:125], v169 offset:50336
    ds_read_b64_tr_b16 v[126:127], v169 offset:52128
    s_waitcnt lgkmcnt(10)
    v_mfma_f32_16x16x32_bf16 v[84:87], v[100:103], a[104:107], v[84:87]
    ds_read_b64_tr_b16 v[128:129], v172 offset:50176
    v_mfma_f32_16x16x32_bf16 v[88:91], v[100:103], a[108:111], v[88:91]
    ds_read_b64_tr_b16 v[130:131], v172 offset:51968
    v_mfma_f32_16x16x32_bf16 v[92:95], v[104:107], a[104:107], v[92:95]
    s_add_u32 s62, s46, 46080
    buffer_load_dwordx4 a[52:55], v10, s[8:11], s62 offen offset:0 sc1
    v_mfma_f32_16x16x32_bf16 v[96:99], v[104:107], a[108:111], v[96:99]
    ds_read_b64_tr_b16 v[100:101], v170 offset:128
    ds_read_b64_tr_b16 v[102:103], v170 offset:1920
    s_waitcnt lgkmcnt(10)
    v_mfma_f32_16x16x32_bf16 v[76:79], v[108:111], a[112:115], v[76:79]
    ds_read_b64_tr_b16 v[104:105], v170 offset:160
    v_mfma_f32_16x16x32_bf16 v[80:83], v[108:111], a[116:119], v[80:83]
    ds_read_b64_tr_b16 v[106:107], v170 offset:1952
    v_mfma_f32_16x16x32_bf16 v[84:87], v[112:115], a[112:115], v[84:87]
    buffer_load_dwordx4 a[56:59], v10, s[8:11], s62 offen offset:1024 sc1
    v_mfma_f32_16x16x32_bf16 v[88:91], v[112:115], a[116:119], v[88:91]
    ds_read_b64_tr_b16 v[108:109], v173 offset:0
    ds_read_b64_tr_b16 v[110:111], v173 offset:1792
    s_waitcnt lgkmcnt(10)
    v_mfma_f32_16x16x32_bf16 v[92:95], v[116:119], a[112:115], v[92:95]
    ds_read_b64_tr_b16 v[112:113], v170 offset:7296
    v_mfma_f32_16x16x32_bf16 v[96:99], v[116:119], a[116:119], v[96:99]
    ds_read_b64_tr_b16 v[114:115], v170 offset:9088
    v_mfma_f32_16x16x32_bf16 v[76:79], v[120:123], a[120:123], v[76:79]
    buffer_load_dwordx4 a[60:63], v10, s[8:11], s62 offen offset:2048 sc1
    v_mfma_f32_16x16x32_bf16 v[80:83], v[120:123], a[124:127], v[80:83]
    ds_read_b64_tr_b16 v[116:117], v170 offset:7328
    ds_read_b64_tr_b16 v[118:119], v170 offset:9120
    s_waitcnt lgkmcnt(10)
    v_mfma_f32_16x16x32_bf16 v[84:87], v[124:127], a[120:123], v[84:87]
    ds_read_b64_tr_b16 v[120:121], v173 offset:7168
    v_mfma_f32_16x16x32_bf16 v[88:91], v[124:127], a[124:127], v[88:91]
    ds_read_b64_tr_b16 v[122:123], v173 offset:8960
    v_mfma_f32_16x16x32_bf16 v[92:95], v[128:131], a[120:123], v[92:95]
    buffer_load_dwordx4 a[64:67], v10, s[8:11], s62 offen offset:3072 sc1
    v_mfma_f32_16x16x32_bf16 v[96:99], v[128:131], a[124:127], v[96:99]
    ds_read_b64_tr_b16 v[124:125], v170 offset:14464
    ds_read_b64_tr_b16 v[126:127], v170 offset:16256
    s_waitcnt lgkmcnt(10)
    v_mfma_f32_16x16x32_bf16 v[76:79], v[100:103], a[128:131], v[76:79]
    ds_read_b64_tr_b16 v[128:129], v170 offset:14496
    v_mfma_f32_16x16x32_bf16 v[80:83], v[100:103], a[132:135], v[80:83]
    ds_read_b64_tr_b16 v[130:131], v170 offset:16288
    v_mfma_f32_16x16x32_bf16 v[84:87], v[104:107], a[128:131], v[84:87]
    s_add_u32 s62, s62, 4096
    buffer_load_dwordx4 a[68:71], v10, s[8:11], s62 offen offset:0 sc1
    v_mfma_f32_16x16x32_bf16 v[88:91], v[104:107], a[132:135], v[88:91]
    ds_read_b64_tr_b16 v[100:101], v173 offset:14336
    ds_read_b64_tr_b16 v[102:103], v173 offset:16128
    s_waitcnt lgkmcnt(10)
    v_mfma_f32_16x16x32_bf16 v[92:95], v[108:111], a[128:131], v[92:95]
    ds_read_b64_tr_b16 v[104:105], v170 offset:21632
    v_mfma_f32_16x16x32_bf16 v[96:99], v[108:111], a[132:135], v[96:99]
    ds_read_b64_tr_b16 v[106:107], v170 offset:23424
    v_mfma_f32_16x16x32_bf16 v[76:79], v[112:115], a[136:139], v[76:79]
    s_add_u32 s62, s46, 51200
    buffer_load_dwordx4 a[72:75], v4, s[8:11], s62 offen offset:0 sc1
    v_mfma_f32_16x16x32_bf16 v[80:83], v[112:115], a[140:143], v[80:83]
    ds_read_b64_tr_b16 v[108:109], v170 offset:21664
    ds_read_b64_tr_b16 v[110:111], v170 offset:23456
    s_waitcnt lgkmcnt(10)
    v_mfma_f32_16x16x32_bf16 v[84:87], v[116:119], a[136:139], v[84:87]
    ds_read_b64_tr_b16 v[112:113], v173 offset:21504
    v_mfma_f32_16x16x32_bf16 v[88:91], v[116:119], a[140:143], v[88:91]
    ds_read_b64_tr_b16 v[114:115], v173 offset:23296
    v_mfma_f32_16x16x32_bf16 v[92:95], v[120:123], a[136:139], v[92:95]
    buffer_load_dwordx4 a[76:79], v4, s[8:11], s62 offen offset:1024 sc1
    v_mfma_f32_16x16x32_bf16 v[96:99], v[120:123], a[140:143], v[96:99]
    s_waitcnt lgkmcnt(8)
    v_mfma_f32_16x16x32_bf16 v[76:79], v[124:127], a[0:3], v[76:79]
    v_mfma_f32_16x16x32_bf16 v[80:83], v[124:127], a[4:7], v[80:83]
    v_mfma_f32_16x16x32_bf16 v[84:87], v[128:131], a[0:3], v[84:87]
    buffer_load_dwordx4 a[80:83], v4, s[8:11], s62 offen offset:2048 sc1
    v_mfma_f32_16x16x32_bf16 v[88:91], v[128:131], a[4:7], v[88:91]
    s_waitcnt lgkmcnt(4)
    v_mfma_f32_16x16x32_bf16 v[92:95], v[100:103], a[0:3], v[92:95]
    v_mfma_f32_16x16x32_bf16 v[96:99], v[100:103], a[4:7], v[96:99]
    v_mfma_f32_16x16x32_bf16 v[76:79], v[104:107], a[8:11], v[76:79]
    buffer_load_dwordx4 a[84:87], v4, s[8:11], s62 offen offset:3072 sc1
    v_mfma_f32_16x16x32_bf16 v[80:83], v[104:107], a[12:15], v[80:83]
    s_waitcnt lgkmcnt(0)
    v_mfma_f32_16x16x32_bf16 v[84:87], v[108:111], a[8:11], v[84:87]
    v_mfma_f32_16x16x32_bf16 v[88:91], v[108:111], a[12:15], v[88:91]
    v_mfma_f32_16x16x32_bf16 v[92:95], v[112:115], a[8:11], v[92:95]
    s_add_u32 s62, s62, 4096
    buffer_load_dwordx4 a[88:91], v4, s[8:11], s62 offen offset:0 sc1
    v_mfma_f32_16x16x32_bf16 v[96:99], v[112:115], a[12:15], v[96:99]
    v_cvt_pk_bf16_f32 v140, v76, v77
    v_cvt_pk_bf16_f32 v141, v78, v79
    s_nop 0
    v_cvt_pk_bf16_f32 v142, v84, v85
    v_cvt_pk_bf16_f32 v143, v86, v87
    v_pk_max_i16 v140, v140, 0
    v_pk_max_i16 v141, v141, 0
    v_pk_max_i16 v142, v142, 0
    v_pk_max_i16 v143, v143, 0
    buffer_store_dwordx4 v[140:143], v4, s[8:11], s14 offen sc1
    v_cvt_pk_bf16_f32 v144, v80, v81
    v_cvt_pk_bf16_f32 v145, v82, v83
    v_cvt_pk_bf16_f32 v146, v88, v89
    v_cvt_pk_bf16_f32 v147, v90, v91
    v_pk_max_i16 v144, v144, 0
    v_pk_max_i16 v145, v145, 0
    v_pk_max_i16 v146, v146, 0
    v_pk_max_i16 v147, v147, 0
    s_add_u32 s14, s14, 57344
    buffer_store_dwordx4 v[144:147], v4, s[8:11], s14 offen sc1
    v_cvt_pk_bf16_f32 v148, v92, v93
    v_cvt_pk_bf16_f32 v149, v94, v95
    v_pk_max_i16 v148, v148, 0
    v_pk_max_i16 v149, v149, 0
    buffer_store_dwordx2 v[148:149], v175, s[8:11], s15 offen sc1
    v_cvt_pk_bf16_f32 v152, v96, v97
    v_cvt_pk_bf16_f32 v153, v98, v99
    v_pk_max_i16 v152, v152, 0
    v_pk_max_i16 v153, v153, 0
    s_add_u32 s15, s15, 57344
    buffer_store_dwordx2 v[152:153], v175, s[8:11], s15 offen sc1
    buffer_load_dword v163, v162, s[8:11], 0 offen sc1
    s_barrier
    buffer_load_dwordx2 v[104:105], v167, s[8:11], s41 offen offset:0 sc1
    buffer_load_dwordx2 v[106:107], v13, s[8:11], s41 offen offset:512 sc1
    buffer_load_dwordx4 v[108:111], v156, s[8:11], s40 offen sc1
    buffer_load_dwordx4 v[112:115], v156, s[8:11], s40 offen offset:1024 sc1
    buffer_load_dwordx2 v[116:117], v157, s[8:11], s43 offen sc1
    s_add_u32 s62, s46, 56320
    buffer_load_dwordx4 a[92:95], v4, s[8:11], s62 offen offset:0 sc1
    buffer_load_dwordx4 a[96:99], v4, s[8:11], s62 offen offset:1024 sc1
    buffer_load_dwordx4 a[100:103], v4, s[8:11], s62 offen offset:2048 sc1
    buffer_load_dwordx4 a[104:107], v4, s[8:11], s62 offen offset:3072 sc1
    s_add_u32 s62, s62, 4096
    buffer_load_dwordx4 a[108:111], v4, s[8:11], s62 offen offset:0 sc1
    s_add_u32 s62, s46, 61440
    buffer_load_dwordx4 a[112:115], v4, s[8:11], s62 offen offset:0 sc1
    buffer_load_dwordx4 a[116:119], v4, s[8:11], s62 offen offset:1024 sc1
    buffer_load_dwordx4 a[120:123], v4, s[8:11], s62 offen offset:2048 sc1
    buffer_load_dwordx4 a[124:127], v4, s[8:11], s62 offen offset:3072 sc1
    s_add_u32 s62, s62, 4096
    buffer_load_dwordx4 a[128:131], v4, s[8:11], s62 offen offset:0 sc1
    s_add_u32 s48, s48, 256
    v_mov_b32 v6, s48
    s_waitcnt vmcnt(16)
    s_mov_b64 exec, 1
    buffer_atomic_add v5, v6, s[8:11], 0 offen sc1
    s_mov_b64 exec, -1
    s_waitcnt vmcnt(16)
    v_cmp_ne_u32 vcc, 8, v163
    s_cbranch_vccz Lok38
    s_mov_b64 exec, 1
    s_mov_b32 s63, 100000
Lpoll39:
    buffer_load_dword v163, v162, s[8:11], 0 offen sc1
    s_sub_u32 s63, s63, 1
    s_cbranch_scc1 Lpolld40
    s_waitcnt vmcnt(0)
    v_cmp_ne_u32 vcc, 8, v163
    s_cbranch_vccz Lpolld40
    s_sleep 2
    s_branch Lpoll39
Lpolld40:
    s_waitcnt vmcnt(0)
    s_mov_b64 exec, -1
Lok38:
    s_add_u32 s3, s34, 0
    buffer_load_dwordx4 a[240:243], v4, s[8:11], s3 offen offset:0 sc1
    s_add_u32 s3, s35, 0
    buffer_load_dwordx4 a[244:247], v4, s[8:11], s3 offen offset:0 sc1
    s_add_u32 s3, s36, 0
    buffer_load_dwordx4 a[248:251], v4, s[8:11], s3 offen offset:0 sc1
    s_add_u32 s3, s37, 0
    buffer_load_dwordx4 a[252:255], v4, s[8:11], s3 offen offset:0 sc1
    s_add_u32 s3, s34, 0
    buffer_load_dwordx4 a[0:3], v4, s[8:11], s3 offen offset:1024 sc1
    s_add_u32 s3, s35, 0
    buffer_load_dwordx4 a[4:7], v4, s[8:11], s3 offen offset:1024 sc1
    s_add_u32 s3, s36, 0
    buffer_load_dwordx4 a[8:11], v4, s[8:11], s3 offen offset:1024 sc1
    s_add_u32 s3, s37, 0
    buffer_load_dwordx4 a[12:15], v4, s[8:11], s3 offen offset:1024 sc1
    s_add_u32 s3, s34, 0
    buffer_load_dwordx4 a[16:19], v4, s[8:11], s3 offen offset:2048 sc1
    s_add_u32 s3, s35, 0
    buffer_load_dwordx4 a[20:23], v4, s[8:11], s3 offen offset:2048 sc1
    s_add_u32 s3, s36, 0
    buffer_load_dwordx4 a[24:27], v4, s[8:11], s3 offen offset:2048 sc1
    s_add_u32 s3, s37, 0
    buffer_load_dwordx4 a[28:31], v4, s[8:11], s3 offen offset:2048 sc1
    v_add_u32 v162, 256, v162
    s_waitcnt vmcnt(8)
    v_mfma_f32_16x16x32_bf16 v[16:19], a[160:163], a[240:243], 0
    s_add_u32 s3, s34, 0
    buffer_load_dwordx4 a[32:35], v4, s[8:11], s3 offen offset:3072 sc1
    v_mfma_f32_16x16x32_bf16 v[20:23], a[164:167], a[240:243], 0
    v_mfma_f32_16x16x32_bf16 v[24:27], a[168:171], a[240:243], 0
    v_mfma_f32_16x16x32_bf16 v[28:31], a[172:175], a[240:243], 0
    v_mfma_f32_16x16x32_bf16 v[32:35], a[176:179], a[240:243], 0
    s_add_u32 s3, s35, 0
    buffer_load_dwordx4 a[36:39], v4, s[8:11], s3 offen offset:3072 sc1
    v_mfma_f32_16x16x32_bf16 v[36:39], a[160:163], a[244:247], 0
    v_mfma_f32_16x16x32_bf16 v[40:43], a[164:167], a[244:247], 0
    v_mfma_f32_16x16x32_bf16 v[44:47], a[168:171], a[244:247], 0
    v_mfma_f32_16x16x32_bf16 v[48:51], a[172:175], a[244:247], 0
    s_add_u32 s3, s36, 0
    buffer_load_dwordx4 a[40:43], v4, s[8:11], s3 offen offset:3072 sc1
    v_mfma_f32_16x16x32_bf16 v[52:55], a[176:179], a[244:247], 0
    v_mfma_f32_16x16x32_bf16 v[56:59], a[160:163], a[248:251], 0
    v_mfma_f32_16x16x32_bf16 v[60:63], a[164:167], a[248:251], 0
    v_mfma_f32_16x16x32_bf16 v[64:67], a[168:171], a[248:251], 0
    s_add_u32 s3, s37, 0
    buffer_load_dwordx4 a[44:47], v4, s[8:11], s3 offen offset:3072 sc1
    v_mfma_f32_16x16x32_bf16 v[68:71], a[172:175], a[248:251], 0
    v_mfma_f32_16x16x32_bf16 v[72:75], a[176:179], a[248:251], 0
    v_mfma_f32_16x16x32_bf16 v[76:79], a[160:163], a[252:255], 0
    v_mfma_f32_16x16x32_bf16 v[80:83], a[164:167], a[252:255], 0
    s_add_u32 s62, s46, 66560
    buffer_load_dwordx4 a[132:135], v4, s[8:11], s62 offen offset:0 sc1
    v_mfma_f32_16x16x32_bf16 v[84:87], a[168:171], a[252:255], 0
    v_mfma_f32_16x16x32_bf16 v[88:91], a[172:175], a[252:255], 0
    v_mfma_f32_16x16x32_bf16 v[92:95], a[176:179], a[252:255], 0
    s_waitcnt vmcnt(9)
    v_mfma_f32_16x16x32_bf16 v[16:19], a[180:183], a[0:3], v[16:19]
    s_add_u32 s3, s34, 4096
    buffer_load_dwordx4 a[240:243], v4, s[8:11], s3 offen offset:0 sc1
    v_mfma_f32_16x16x32_bf16 v[20:23], a[184:187], a[0:3], v[20:23]
    v_mfma_f32_16x16x32_bf16 v[24:27], a[188:191], a[0:3], v[24:27]
    v_mfma_f32_16x16x32_bf16 v[28:31], a[192:195], a[0:3], v[28:31]
    v_mfma_f32_16x16x32_bf16 v[32:35], a[196:199], a[0:3], v[32:35]
    s_add_u32 s3, s35, 4096
    buffer_load_dwordx4 a[244:247], v4, s[8:11], s3 offen offset:0 sc1
    v_mfma_f32_16x16x32_bf16 v[36:39], a[180:183], a[4:7], v[36:39]
    v_mfma_f32_16x16x32_bf16 v[40:43], a[184:187], a[4:7], v[40:43]
    v_mfma_f32_16x16x32_bf16 v[44:47], a[188:191], a[4:7], v[44:47]
    v_mfma_f32_16x16x32_bf16 v[48:51], a[192:195], a[4:7], v[48:51]
    s_add_u32 s3, s36, 4096
    buffer_load_dwordx4 a[248:251], v4, s[8:11], s3 offen offset:0 sc1
    v_mfma_f32_16x16x32_bf16 v[52:55], a[196:199], a[4:7], v[52:55]
    v_mfma_f32_16x16x32_bf16 v[56:59], a[180:183], a[8:11], v[56:59]
    v_mfma_f32_16x16x32_bf16 v[60:63], a[184:187], a[8:11], v[60:63]
    v_mfma_f32_16x16x32_bf16 v[64:67], a[188:191], a[8:11], v[64:67]
    s_add_u32 s3, s37, 4096
    buffer_load_dwordx4 a[252:255], v4, s[8:11], s3 offen offset:0 sc1
    v_mfma_f32_16x16x32_bf16 v[68:71], a[192:195], a[8:11], v[68:71]
    v_mfma_f32_16x16x32_bf16 v[72:75], a[196:199], a[8:11], v[72:75]
    v_mfma_f32_16x16x32_bf16 v[76:79], a[180:183], a[12:15], v[76:79]
    v_mfma_f32_16x16x32_bf16 v[80:83], a[184:187], a[12:15], v[80:83]
    buffer_load_dwordx4 a[136:139], v4, s[8:11], s62 offen offset:1024 sc1
    v_mfma_f32_16x16x32_bf16 v[84:87], a[188:191], a[12:15], v[84:87]
    v_mfma_f32_16x16x32_bf16 v[88:91], a[192:195], a[12:15], v[88:91]
    v_mfma_f32_16x16x32_bf16 v[92:95], a[196:199], a[12:15], v[92:95]
    buffer_load_dword v163, v162, s[8:11], 0 offen sc1
    s_waitcnt vmcnt(11)
    v_mfma_f32_16x16x32_bf16 v[16:19], a[200:203], a[16:19], v[16:19]
    s_add_u32 s3, s34, 4096
    buffer_load_dwordx4 a[0:3], v4, s[8:11], s3 offen offset:1024 sc1
    v_mfma_f32_16x16x32_bf16 v[20:23], a[204:207], a[16:19], v[20:23]
    v_mfma_f32_16x16x32_bf16 v[24:27], a[208:211], a[16:19], v[24:27]
    v_mfma_f32_16x16x32_bf16 v[28:31], a[212:215], a[16:19], v[28:31]
    v_mfma_f32_16x16x32_bf16 v[32:35], a[216:219], a[16:19], v[32:35]
    s_add_u32 s3, s35, 4096
    buffer_load_dwordx4 a[4:7], v4, s[8:11], s3 offen offset:1024 sc1
    v_mfma_f32_16x16x32_bf16 v[36:39], a[200:203], a[20:23], v[36:39]
    v_mfma_f32_16x16x32_bf16 v[40:43], a[204:207], a[20:23], v[40:43]
    v_mfma_f32_16x16x32_bf16 v[44:47], a[208:211], a[20:23], v[44:47]
    v_mfma_f32_16x16x32_bf16 v[48:51], a[212:215], a[20:23], v[48:51]
    s_add_u32 s3, s36, 4096
    buffer_load_dwordx4 a[8:11], v4, s[8:11], s3 offen offset:1024 sc1
    v_mfma_f32_16x16x32_bf16 v[52:55], a[216:219], a[20:23], v[52:55]
    v_mfma_f32_16x16x32_bf16 v[56:59], a[200:203], a[24:27], v[56:59]
    v_mfma_f32_16x16x32_bf16 v[60:63], a[204:207], a[24:27], v[60:63]
    v_mfma_f32_16x16x32_bf16 v[64:67], a[208:211], a[24:27], v[64:67]
    s_add_u32 s3, s37, 4096
    buffer_load_dwordx4 a[12:15], v4, s[8:11], s3 offen offset:1024 sc1
    v_mfma_f32_16x16x32_bf16 v[68:71], a[212:215], a[24:27], v[68:71]
    v_mfma_f32_16x16x32_bf16 v[72:75], a[216:219], a[24:27], v[72:75]
    v_mfma_f32_16x16x32_bf16 v[76:79], a[200:203], a[28:31], v[76:79]
    v_mfma_f32_16x16x32_bf16 v[80:83], a[204:207], a[28:31], v[80:83]
    buffer_load_dwordx4 a[140:143], v4, s[8:11], s62 offen offset:2048 sc1
    v_mfma_f32_16x16x32_bf16 v[84:87], a[208:211], a[28:31], v[84:87]
    v_mfma_f32_16x16x32_bf16 v[88:91], a[212:215], a[28:31], v[88:91]
    v_mfma_f32_16x16x32_bf16 v[92:95], a[216:219], a[28:31], v[92:95]
    s_waitcnt vmcnt(12)
    v_mfma_f32_16x16x32_bf16 v[16:19], a[220:223], a[32:35], v[16:19]
    s_add_u32 s3, s34, 4096
    buffer_load_dwordx4 a[16:19], v4, s[8:11], s3 offen offset:2048 sc1
    v_mfma_f32_16x16x32_bf16 v[20:23], a[224:227], a[32:35], v[20:23]
    v_mfma_f32_16x16x32_bf16 v[24:27], a[228:231], a[32:35], v[24:27]
    v_mfma_f32_16x16x32_bf16 v[28:31], a[232:235], a[32:35], v[28:31]
    v_mfma_f32_16x16x32_bf16 v[32:35], a[236:239], a[32:35], v[32:35]
    s_add_u32 s3, s35, 4096
    buffer_load_dwordx4 a[20:23], v4, s[8:11], s3 offen offset:2048 sc1
    v_mfma_f32_16x16x32_bf16 v[36:39], a[220:223], a[36:39], v[36:39]
    v_mfma_f32_16x16x32_bf16 v[40:43], a[224:227], a[36:39], v[40:43]
    v_mfma_f32_16x16x32_bf16 v[44:47], a[228:231], a[36:39], v[44:47]
    v_mfma_f32_16x16x32_bf16 v[48:51], a[232:235], a[36:39], v[48:51]
    s_add_u32 s3, s36, 4096
    buffer_load_dwordx4 a[24:27], v4, s[8:11], s3 offen offset:2048 sc1
    v_mfma_f32_16x16x32_bf16 v[52:55], a[236:239], a[36:39], v[52:55]
    v_mfma_f32_16x16x32_bf16 v[56:59], a[220:223], a[40:43], v[56:59]
    v_mfma_f32_16x16x32_bf16 v[60:63], a[224:227], a[40:43], v[60:63]
    v_mfma_f32_16x16x32_bf16 v[64:67], a[228:231], a[40:43], v[64:67]
    s_add_u32 s3, s37, 4096
    buffer_load_dwordx4 a[28:31], v4, s[8:11], s3 offen offset:2048 sc1
    v_mfma_f32_16x16x32_bf16 v[68:71], a[232:235], a[40:43], v[68:71]
    v_mfma_f32_16x16x32_bf16 v[72:75], a[236:239], a[40:43], v[72:75]
    v_mfma_f32_16x16x32_bf16 v[76:79], a[220:223], a[44:47], v[76:79]
    v_mfma_f32_16x16x32_bf16 v[80:83], a[224:227], a[44:47], v[80:83]
    buffer_load_dwordx4 v[132:135], v4, s[8:11], s62 offen offset:3072 sc1
    v_mfma_f32_16x16x32_bf16 v[84:87], a[228:231], a[44:47], v[84:87]
    v_mfma_f32_16x16x32_bf16 v[88:91], a[232:235], a[44:47], v[88:91]
    v_mfma_f32_16x16x32_bf16 v[92:95], a[236:239], a[44:47], v[92:95]
    s_waitcnt vmcnt(12)
    v_mfma_f32_16x16x32_bf16 v[16:19], v[176:179], a[240:243], v[16:19]
    s_add_u32 s3, s34, 4096
    buffer_load_dwordx4 a[32:35], v4, s[8:11], s3 offen offset:3072 sc1
    v_mfma_f32_16x16x32_bf16 v[20:23], v[180:183], a[240:243], v[20:23]
    v_mfma_f32_16x16x32_bf16 v[24:27], v[184:187], a[240:243], v[24:27]
    v_mfma_f32_16x16x32_bf16 v[28:31], v[188:191], a[240:243], v[28:31]
    v_mfma_f32_16x16x32_bf16 v[32:35], v[192:195], a[240:243], v[32:35]
    s_add_u32 s3, s35, 4096
    buffer_load_dwordx4 a[36:39], v4, s[8:11], s3 offen offset:3072 sc1
    v_mfma_f32_16x16x32_bf16 v[36:39], v[176:179], a[244:247], v[36:39]
    v_mfma_f32_16x16x32_bf16 v[40:43], v[180:183], a[244:247], v[40:43]
    v_mfma_f32_16x16x32_bf16 v[44:47], v[184:187], a[244:247], v[44:47]
    v_mfma_f32_16x16x32_bf16 v[48:51], v[188:191], a[244:247], v[48:51]
    s_add_u32 s3, s36, 4096
    buffer_load_dwordx4 a[40:43], v4, s[8:11], s3 offen offset:3072 sc1
    v_mfma_f32_16x16x32_bf16 v[52:55], v[192:195], a[244:247], v[52:55]
    v_mfma_f32_16x16x32_bf16 v[56:59], v[176:179], a[248:251], v[56:59]
    v_mfma_f32_16x16x32_bf16 v[60:63], v[180:183], a[248:251], v[60:63]
    v_mfma_f32_16x16x32_bf16 v[64:67], v[184:187], a[248:251], v[64:67]
    s_add_u32 s3, s37, 4096
    buffer_load_dwordx4 a[44:47], v4, s[8:11], s3 offen offset:3072 sc1
    v_mfma_f32_16x16x32_bf16 v[68:71], v[188:191], a[248:251], v[68:71]
    v_mfma_f32_16x16x32_bf16 v[72:75], v[192:195], a[248:251], v[72:75]
    v_mfma_f32_16x16x32_bf16 v[76:79], v[176:179], a[252:255], v[76:79]
    v_mfma_f32_16x16x32_bf16 v[80:83], v[180:183], a[252:255], v[80:83]
    s_add_u32 s62, s62, 4096
    buffer_load_dwordx4 v[136:139], v4, s[8:11], s62 offen offset:0 sc1
    v_mfma_f32_16x16x32_bf16 v[84:87], v[184:187], a[252:255], v[84:87]
    v_mfma_f32_16x16x32_bf16 v[88:91], v[188:191], a[252:255], v[88:91]
    v_mfma_f32_16x16x32_bf16 v[92:95], v[192:195], a[252:255], v[92:95]
    s_waitcnt vmcnt(15)
    v_cmp_ne_u32 vcc, 8, v163
    s_cbranch_vccz Lok41
    s_mov_b64 exec, 1
    s_mov_b32 s63, 100000
Lpoll42:
    buffer_load_dword v163, v162, s[8:11], 0 offen sc1
    s_sub_u32 s63, s63, 1
    s_cbranch_scc1 Lpolld43
    s_waitcnt vmcnt(0)
    v_cmp_ne_u32 vcc, 8, v163
    s_cbranch_vccz Lpolld43
    s_sleep 2
    s_branch Lpoll42
Lpolld43:
    s_waitcnt vmcnt(0)
    s_mov_b64 exec, -1
Lok41:
    s_waitcnt vmcnt(11)
    v_mfma_f32_16x16x32_bf16 v[16:19], v[196:199], a[0:3], v[16:19]
    s_add_u32 s3, s34, 8192
    buffer_load_dwordx2 a[240:241], v14, s[8:11], s3 offen offset:0 sc1
    buffer_load_dwordx2 a[242:243], v14, s[8:11], s3 offen offset:512 sc1
    v_mfma_f32_16x16x32_bf16 v[20:23], v[200:203], a[0:3], v[20:23]
    v_mfma_f32_16x16x32_bf16 v[24:27], v[204:207], a[0:3], v[24:27]
    v_mfma_f32_16x16x32_bf16 v[28:31], v[208:211], a[0:3], v[28:31]
    v_mfma_f32_16x16x32_bf16 v[32:35], v[212:215], a[0:3], v[32:35]
    v_mfma_f32_16x16x32_bf16 v[36:39], v[196:199], a[4:7], v[36:39]
    s_add_u32 s3, s35, 8192
    buffer_load_dwordx2 a[244:245], v14, s[8:11], s3 offen offset:0 sc1
    buffer_load_dwordx2 a[246:247], v14, s[8:11], s3 offen offset:512 sc1
    v_mfma_f32_16x16x32_bf16 v[40:43], v[200:203], a[4:7], v[40:43]
    v_mfma_f32_16x16x32_bf16 v[44:47], v[204:207], a[4:7], v[44:47]
    v_mfma_f32_16x16x32_bf16 v[48:51], v[208:211], a[4:7], v[48:51]
    v_mfma_f32_16x16x32_bf16 v[52:55], v[212:215], a[4:7], v[52:55]
    v_mfma_f32_16x16x32_bf16 v[56:59], v[196:199], a[8:11], v[56:59]
    s_add_u32 s3, s36, 8192
    buffer_load_dwordx2 a[248:249], v14, s[8:11], s3 offen offset:0 sc1
    buffer_load_dwordx2 a[250:251], v14, s[8:11], s3 offen offset:512 sc1
    v_mfma_f32_16x16x32_bf16 v[60:63], v[200:203], a[8:11], v[60:63]
    v_mfma_f32_16x16x32_bf16 v[64:67], v[204:207], a[8:11], v[64:67]
    v_mfma_f32_16x16x32_bf16 v[68:71], v[208:211], a[8:11], v[68:71]
    v_mfma_f32_16x16x32_bf16 v[72:75], v[212:215], a[8:11], v[72:75]
    v_mfma_f32_16x16x32_bf16 v[76:79], v[196:199], a[12:15], v[76:79]
    s_add_u32 s3, s37, 8192
    buffer_load_dwordx2 a[252:253], v14, s[8:11], s3 offen offset:0 sc1
    buffer_load_dwordx2 a[254:255], v14, s[8:11], s3 offen offset:512 sc1
    v_mfma_f32_16x16x32_bf16 v[80:83], v[200:203], a[12:15], v[80:83]
    v_mfma_f32_16x16x32_bf16 v[84:87], v[204:207], a[12:15], v[84:87]
    v_mfma_f32_16x16x32_bf16 v[88:91], v[208:211], a[12:15], v[88:91]
    v_mfma_f32_16x16x32_bf16 v[92:95], v[212:215], a[12:15], v[92:95]
    s_waitcnt vmcnt(14)
    v_mfma_f32_16x16x32_bf16 v[16:19], v[216:219], a[16:19], v[16:19]
    s_add_u32 s3, s34, 8192
    buffer_load_dwordx2 a[0:1], v14, s[8:11], s3 offen offset:1024 sc1
    buffer_load_dwordx2 a[2:3], v14, s[8:11], s3 offen offset:1536 sc1
    v_mfma_f32_16x16x32_bf16 v[20:23], v[220:223], a[16:19], v[20:23]
    v_mfma_f32_16x16x32_bf16 v[24:27], v[224:227], a[16:19], v[24:27]
    v_mfma_f32_16x16x32_bf16 v[28:31], v[228:231], a[16:19], v[28:31]
    v_mfma_f32_16x16x32_bf16 v[32:35], v[232:235], a[16:19], v[32:35]
    v_mfma_f32_16x16x32_bf16 v[36:39], v[216:219], a[20:23], v[36:39]
    s_add_u32 s3, s35, 8192
    buffer_load_dwordx2 a[4:5], v14, s[8:11], s3 offen offset:1024 sc1
    buffer_load_dwordx2 a[6:7], v14, s[8:11], s3 offen offset:1536 sc1
    v_mfma_f32_16x16x32_bf16 v[40:43], v[220:223], a[20:23], v[40:43]
    v_mfma_f32_16x16x32_bf16 v[44:47], v[224:227], a[20:23], v[44:47]
    v_mfma_f32_16x16x32_bf16 v[48:51], v[228:231], a[20:23], v[48:51]
    v_mfma_f32_16x16x32_bf16 v[52:55], v[232:235], a[20:23], v[52:55]
    v_mfma_f32_16x16x32_bf16 v[56:59], v[216:219], a[24:27], v[56:59]
    s_add_u32 s3, s36, 8192
    buffer_load_dwordx2 a[8:9], v14, s[8:11], s3 offen offset:1024 sc1
    buffer_load_dwordx2 a[10:11], v14, s[8:11], s3 offen offset:1536 sc1
    v_mfma_f32_16x16x32_bf16 v[60:63], v[220:223], a[24:27], v[60:63]
    v_mfma_f32_16x16x32_bf16 v[64:67], v[224:227], a[24:27], v[64:67]
    v_mfma_f32_16x16x32_bf16 v[68:71], v[228:231], a[24:27], v[68:71]
    v_mfma_f32_16x16x32_bf16 v[72:75], v[232:235], a[24:27], v[72:75]
    v_mfma_f32_16x16x32_bf16 v[76:79], v[216:219], a[28:31], v[76:79]
    s_add_u32 s3, s37, 8192
    buffer_load_dwordx2 a[12:13], v14, s[8:11], s3 offen offset:1024 sc1
    buffer_load_dwordx2 a[14:15], v14, s[8:11], s3 offen offset:1536 sc1
    v_mfma_f32_16x16x32_bf16 v[80:83], v[220:223], a[28:31], v[80:83]
    v_mfma_f32_16x16x32_bf16 v[84:87], v[224:227], a[28:31], v[84:87]
    v_mfma_f32_16x16x32_bf16 v[88:91], v[228:231], a[28:31], v[88:91]
    v_mfma_f32_16x16x32_bf16 v[92:95], v[232:235], a[28:31], v[92:95]
    s_waitcnt vmcnt(17)
    v_mfma_f32_16x16x32_bf16 v[16:19], v[236:239], a[32:35], v[16:19]
    s_add_u32 s3, s34, 8192
    buffer_load_dwordx4 a[160:163], v4, s[8:11], s3 offen offset:2048 sc1
    v_mfma_f32_16x16x32_bf16 v[20:23], v[240:243], a[32:35], v[20:23]
    v_mfma_f32_16x16x32_bf16 v[24:27], v[244:247], a[32:35], v[24:27]
    v_mfma_f32_16x16x32_bf16 v[28:31], v[248:251], a[32:35], v[28:31]
    v_mfma_f32_16x16x32_bf16 v[32:35], v[252:255], a[32:35], v[32:35]
    v_mfma_f32_16x16x32_bf16 v[36:39], v[236:239], a[36:39], v[36:39]
    s_add_u32 s3, s34, 8192
    buffer_load_dwordx4 a[176:179], v4, s[8:11], s3 offen offset:3072 sc1
    v_mfma_f32_16x16x32_bf16 v[40:43], v[240:243], a[36:39], v[40:43]
    v_mfma_f32_16x16x32_bf16 v[44:47], v[244:247], a[36:39], v[44:47]
    v_mfma_f32_16x16x32_bf16 v[48:51], v[248:251], a[36:39], v[48:51]
    v_mfma_f32_16x16x32_bf16 v[52:55], v[252:255], a[36:39], v[52:55]
    v_mfma_f32_16x16x32_bf16 v[56:59], v[236:239], a[40:43], v[56:59]
    s_add_u32 s3, s34, 12288
    buffer_load_dwordx4 a[192:195], v4, s[8:11], s3 offen offset:0 sc1
    v_mfma_f32_16x16x32_bf16 v[60:63], v[240:243], a[40:43], v[60:63]
    v_mfma_f32_16x16x32_bf16 v[64:67], v[244:247], a[40:43], v[64:67]
    v_mfma_f32_16x16x32_bf16 v[68:71], v[248:251], a[40:43], v[68:71]
    v_mfma_f32_16x16x32_bf16 v[72:75], v[252:255], a[40:43], v[72:75]
    v_mfma_f32_16x16x32_bf16 v[76:79], v[236:239], a[44:47], v[76:79]
    s_add_u32 s3, s34, 12288
    buffer_load_dwordx4 a[208:211], v4, s[8:11], s3 offen offset:1024 sc1
    v_mfma_f32_16x16x32_bf16 v[80:83], v[240:243], a[44:47], v[80:83]
    v_mfma_f32_16x16x32_bf16 v[84:87], v[244:247], a[44:47], v[84:87]
    v_mfma_f32_16x16x32_bf16 v[88:91], v[248:251], a[44:47], v[88:91]
    v_mfma_f32_16x16x32_bf16 v[92:95], v[252:255], a[44:47], v[92:95]
    s_waitcnt vmcnt(12)
    v_mfma_f32_16x16x32_bf16 v[16:19], a[144:147], a[240:243], v[16:19]
    s_add_u32 s3, s35, 8192
    buffer_load_dwordx4 a[164:167], v4, s[8:11], s3 offen offset:2048 sc1
    v_mfma_f32_16x16x32_bf16 v[20:23], a[148:151], a[240:243], v[20:23]
    v_mfma_f32_16x16x32_bf16 v[24:27], a[152:155], a[240:243], v[24:27]
    v_mfma_f32_16x16x32_bf16 v[28:31], a[156:159], a[240:243], v[28:31]
    v_mfma_f32_16x16x32_bf16 v[32:35], a[48:51], a[240:243], v[32:35]
    v_mfma_f32_16x16x32_bf16 v[36:39], a[144:147], a[244:247], v[36:39]
    s_add_u32 s3, s35, 8192
    buffer_load_dwordx4 a[180:183], v4, s[8:11], s3 offen offset:3072 sc1
    v_mfma_f32_16x16x32_bf16 v[40:43], a[148:151], a[244:247], v[40:43]
    v_mfma_f32_16x16x32_bf16 v[44:47], a[152:155], a[244:247], v[44:47]
    v_mfma_f32_16x16x32_bf16 v[48:51], a[156:159], a[244:247], v[48:51]
    v_mfma_f32_16x16x32_bf16 v[52:55], a[48:51], a[244:247], v[52:55]
    v_mfma_f32_16x16x32_bf16 v[56:59], a[144:147], a[248:251], v[56:59]
    s_add_u32 s3, s35, 12288
    buffer_load_dwordx4 a[196:199], v4, s[8:11], s3 offen offset:0 sc1
    v_mfma_f32_16x16x32_bf16 v[60:63], a[148:151], a[248:251], v[60:63]
    v_mfma_f32_16x16x32_bf16 v[64:67], a[152:155], a[248:251], v[64:67]
    v_mfma_f32_16x16x32_bf16 v[68:71], a[156:159], a[248:251], v[68:71]
    v_mfma_f32_16x16x32_bf16 v[72:75], a[48:51], a[248:251], v[72:75]
    v_mfma_f32_16x16x32_bf16 v[76:79], a[144:147], a[252:255], v[76:79]
    s_add_u32 s3, s35, 12288
    buffer_load_dwordx4 a[212:215], v4, s[8:11], s3 offen offset:1024 sc1
    v_mfma_f32_16x16x32_bf16 v[80:83], a[148:151], a[252:255], v[80:83]
    v_mfma_f32_16x16x32_bf16 v[84:87], a[152:155], a[252:255], v[84:87]
    v_mfma_f32_16x16x32_bf16 v[88:91], a[156:159], a[252:255], v[88:91]
    v_mfma_f32_16x16x32_bf16 v[92:95], a[48:51], a[252:255], v[92:95]
    s_waitcnt vmcnt(8)
    v_mfma_f32_16x16x32_bf16 v[16:19], a[52:55], a[0:3], v[16:19]
    s_add_u32 s3, s36, 8192
    buffer_load_dwordx4 a[168:171], v4, s[8:11], s3 offen offset:2048 sc1
    v_mfma_f32_16x16x32_bf16 v[20:23], a[56:59], a[0:3], v[20:23]
    v_mfma_f32_16x16x32_bf16 v[24:27], a[60:63], a[0:3], v[24:27]
    v_mfma_f32_16x16x32_bf16 v[28:31], a[64:67], a[0:3], v[28:31]
    v_mfma_f32_16x16x32_bf16 v[32:35], a[68:71], a[0:3], v[32:35]
    v_mfma_f32_16x16x32_bf16 v[36:39], a[52:55], a[4:7], v[36:39]
    s_add_u32 s3, s36, 8192
    buffer_load_dwordx4 a[184:187], v4, s[8:11], s3 offen offset:3072 sc1
    v_mfma_f32_16x16x32_bf16 v[40:43], a[56:59], a[4:7], v[40:43]
    v_mfma_f32_16x16x32_bf16 v[44:47], a[60:63], a[4:7], v[44:47]
    v_mfma_f32_16x16x32_bf16 v[48:51], a[64:67], a[4:7], v[48:51]
    v_mfma_f32_16x16x32_bf16 v[52:55], a[68:71], a[4:7], v[52:55]
    v_mfma_f32_16x16x32_bf16 v[56:59], a[52:55], a[8:11], v[56:59]
    s_add_u32 s3, s36, 12288
    buffer_load_dwordx4 a[200:203], v4, s[8:11], s3 offen offset:0 sc1
    v_mfma_f32_16x16x32_bf16 v[60:63], a[56:59], a[8:11], v[60:63]
    v_mfma_f32_16x16x32_bf16 v[64:67], a[60:63], a[8:11], v[64:67]
    v_mfma_f32_16x16x32_bf16 v[68:71], a[64:67], a[8:11], v[68:71]
    v_mfma_f32_16x16x32_bf16 v[72:75], a[68:71], a[8:11], v[72:75]
    v_mfma_f32_16x16x32_bf16 v[76:79], a[52:55], a[12:15], v[76:79]
    s_add_u32 s3, s36, 12288
    buffer_load_dwordx4 a[216:219], v4, s[8:11], s3 offen offset:1024 sc1
    v_mfma_f32_16x16x32_bf16 v[80:83], a[56:59], a[12:15], v[80:83]
    v_mfma_f32_16x16x32_bf16 v[84:87], a[60:63], a[12:15], v[84:87]
    v_mfma_f32_16x16x32_bf16 v[88:91], a[64:67], a[12:15], v[88:91]
    v_mfma_f32_16x16x32_bf16 v[92:95], a[68:71], a[12:15], v[92:95]
    s_waitcnt vmcnt(11)
    v_mfma_f32_16x16x32_bf16 v[16:19], a[72:75], a[160:163], v[16:19]
    s_add_u32 s3, s37, 8192
    buffer_load_dwordx4 a[172:175], v4, s[8:11], s3 offen offset:2048 sc1
    v_mfma_f32_16x16x32_bf16 v[20:23], a[76:79], a[160:163], v[20:23]
    v_add_f32 v11, v104, v106
    v_mfma_f32_16x16x32_bf16 v[24:27], a[80:83], a[160:163], v[24:27]
    v_add_f32 v12, v105, v107
    v_mfma_f32_16x16x32_bf16 v[28:31], a[84:87], a[160:163], v[28:31]
    s_nop 0
    v_permlane32_swap_b32 v11, v12
    v_mfma_f32_16x16x32_bf16 v[32:35], a[88:91], a[160:163], v[32:35]
    v_add_f32 v11, v11, v12
    s_waitcnt vmcnt(11)
    v_mfma_f32_16x16x32_bf16 v[16:19], a[92:95], a[176:179], v[16:19]
    s_add_u32 s3, s37, 8192
    buffer_load_dwordx4 a[188:191], v4, s[8:11], s3 offen offset:3072 sc1
    v_mfma_f32_16x16x32_bf16 v[20:23], a[96:99], a[176:179], v[20:23]
    v_mov_b32 v12, v11
    v_mfma_f32_16x16x32_bf16 v[24:27], a[100:103], a[176:179], v[24:27]
    s_nop 0
    v_permlane16_swap_b32 v11, v12
    v_mfma_f32_16x16x32_bf16 v[28:31], a[104:107], a[176:179], v[28:31]
    v_add_f32 v11, v11, v12
    v_mfma_f32_16x16x32_bf16 v[32:35], a[108:111], a[176:179], v[32:35]
    v_mov_b32 v12, v11
    s_waitcnt vmcnt(11)
    v_mfma_f32_16x16x32_bf16 v[16:19], a[112:115], a[192:195], v[16:19]
    s_add_u32 s3, s37, 12288
    buffer_load_dwordx4 a[204:207], v4, s[8:11], s3 offen offset:0 sc1
    v_mfma_f32_16x16x32_bf16 v[20:23], a[116:119], a[192:195], v[20:23]
    v_permlane32_swap_b32 v11, v12
    v_mfma_f32_16x16x32_bf16 v[24:27], a[120:123], a[192:195], v[24:27]
    v_mul_f32 v11, 0x3acccccd, v11
    v_mfma_f32_16x16x32_bf16 v[28:31], a[124:127], a[192:195], v[28:31]
    v_mul_f32 v12, 0x3acccccd, v12
    v_mfma_f32_16x16x32_bf16 v[32:35], a[128:131], a[192:195], v[32:35]
    v_fma_f32 v12, -v11, v11, v12
    s_waitcnt vmcnt(11)
    v_mfma_f32_16x16x32_bf16 v[16:19], a[132:135], a[208:211], v[16:19]
    s_add_u32 s3, s37, 12288
    buffer_load_dwordx4 a[220:223], v4, s[8:11], s3 offen offset:1024 sc1
    v_mfma_f32_16x16x32_bf16 v[20:23], a[136:139], a[208:211], v[20:23]
    v_max_f32 v12, 0, v12
    v_mfma_f32_16x16x32_bf16 v[24:27], a[140:143], a[208:211], v[24:27]
    v_add_f32 v12, 0x3727c5ac, v12
    v_mfma_f32_16x16x32_bf16 v[28:31], v[132:135], a[208:211], v[28:31]
    v_rsq_f32 v12, v12
    v_mfma_f32_16x16x32_bf16 v[32:35], v[136:139], a[208:211], v[32:35]
    v_lshlrev_b32 v176, 16, v108
    s_waitcnt vmcnt(11)
    v_mfma_f32_16x16x32_bf16 v[36:39], a[72:75], a[164:167], v[36:39]
    v_and_b32 v177, 0xffff0000, v108
    v_mfma_f32_16x16x32_bf16 v[40:43], a[76:79], a[164:167], v[40:43]
    v_lshlrev_b32 v178, 16, v109
    v_mfma_f32_16x16x32_bf16 v[44:47], a[80:83], a[164:167], v[44:47]
    v_and_b32 v179, 0xffff0000, v109
    v_mfma_f32_16x16x32_bf16 v[48:51], a[84:87], a[164:167], v[48:51]
    ds_write_b128 v158, v[16:19] offset:0
    v_mfma_f32_16x16x32_bf16 v[52:55], a[88:91], a[164:167], v[52:55]
    v_lshlrev_b32 v180, 16, v110
    s_waitcnt vmcnt(10)
    v_mfma_f32_16x16x32_bf16 v[36:39], a[92:95], a[180:183], v[36:39]
    v_and_b32 v181, 0xffff0000, v110
    v_mfma_f32_16x16x32_bf16 v[40:43], a[96:99], a[180:183], v[40:43]
    ds_write_b128 v158, v[20:23] offset:1024
    v_mfma_f32_16x16x32_bf16 v[44:47], a[100:103], a[180:183], v[44:47]
    v_lshlrev_b32 v182, 16, v111
    v_mfma_f32_16x16x32_bf16 v[48:51], a[104:107], a[180:183], v[48:51]
    v_and_b32 v183, 0xffff0000, v111
    v_mfma_f32_16x16x32_bf16 v[52:55], a[108:111], a[180:183], v[52:55]
    ds_write_b128 v158, v[24:27] offset:2048
    s_waitcnt vmcnt(9)
    v_mfma_f32_16x16x32_bf16 v[36:39], a[112:115], a[196:199], v[36:39]
    v_lshlrev_b32 v184, 16, v112
    v_mfma_f32_16x16x32_bf16 v[40:43], a[116:119], a[196:199], v[40:43]
    v_and_b32 v185, 0xffff0000, v112
    v_mfma_f32_16x16x32_bf16 v[44:47], a[120:123], a[196:199], v[44:47]
    ds_write_b128 v158, v[28:31] offset:3072
    v_mfma_f32_16x16x32_bf16 v[48:51], a[124:127], a[196:199], v[48:51]
    v_lshlrev_b32 v186, 16, v113
    v_mfma_f32_16x16x32_bf16 v[52:55], a[128:131], a[196:199], v[52:55]
    v_and_b32 v187, 0xffff0000, v113
    s_waitcnt vmcnt(8)
    v_mfma_f32_16x16x32_bf16 v[36:39], a[132:135], a[212:215], v[36:39]
    ds_write_b128 v158, v[32:35] offset:4096
    v_mfma_f32_16x16x32_bf16 v[40:43], a[136:139], a[212:215], v[40:43]
    v_lshlrev_b32 v188, 16, v114
    v_mfma_f32_16x16x32_bf16 v[44:47], a[140:143], a[212:215], v[44:47]
    v_and_b32 v189, 0xffff0000, v114
    v_mfma_f32_16x16x32_bf16 v[48:51], v[132:135], a[212:215], v[48:51]
    v_lshlrev_b32 v190, 16, v115
    v_mfma_f32_16x16x32_bf16 v[52:55], v[136:139], a[212:215], v[52:55]
    v_and_b32 v191, 0xffff0000, v115
    s_waitcnt vmcnt(7)
    v_mfma_f32_16x16x32_bf16 v[56:59], a[72:75], a[168:171], v[56:59]
    v_lshlrev_b32 v192, 16, v116
    v_mfma_f32_16x16x32_bf16 v[60:63], a[76:79], a[168:171], v[60:63]
    v_and_b32 v193, 0xffff0000, v116
    v_mfma_f32_16x16x32_bf16 v[64:67], a[80:83], a[168:171], v[64:67]
    v_lshlrev_b32 v194, 16, v117
    v_mfma_f32_16x16x32_bf16 v[68:71], a[84:87], a[168:171], v[68:71]
    ds_write_b128 v159, v[36:39] offset:5120
    v_mfma_f32_16x16x32_bf16 v[72:75], a[88:91], a[168:171], v[72:75]
    v_and_b32 v195, 0xffff0000, v117
    s_waitcnt vmcnt(6)
    v_mfma_f32_16x16x32_bf16 v[56:59], a[92:95], a[184:187], v[56:59]
    v_mfma_f32_16x16x32_bf16 v[60:63], a[96:99], a[184:187], v[60:63]
    ds_write_b128 v159, v[40:43] offset:6144
    v_mfma_f32_16x16x32_bf16 v[64:67], a[100:103], a[184:187], v[64:67]
    v_mfma_f32_16x16x32_bf16 v[68:71], a[104:107], a[184:187], v[68:71]
    v_mfma_f32_16x16x32_bf16 v[72:75], a[108:111], a[184:187], v[72:75]
    ds_write_b128 v159, v[44:47] offset:7168
    s_waitcnt vmcnt(5)
    v_mfma_f32_16x16x32_bf16 v[56:59], a[112:115], a[200:203], v[56:59]
    v_mfma_f32_16x16x32_bf16 v[60:63], a[116:119], a[200:203], v[60:63]
    v_mfma_f32_16x16x32_bf16 v[64:67], a[120:123], a[200:203], v[64:67]
    ds_write_b128 v159, v[48:51] offset:8192
    v_mfma_f32_16x16x32_bf16 v[68:71], a[124:127], a[200:203], v[68:71]
    v_mfma_f32_16x16x32_bf16 v[72:75], a[128:131], a[200:203], v[72:75]
    s_waitcnt vmcnt(4)
    v_mfma_f32_16x16x32_bf16 v[56:59], a[132:135], a[216:219], v[56:59]
    ds_write_b128 v159, v[52:55] offset:9216
    v_mfma_f32_16x16x32_bf16 v[60:63], a[136:139], a[216:219], v[60:63]
    v_mfma_f32_16x16x32_bf16 v[64:67], a[140:143], a[216:219], v[64:67]
    v_mfma_f32_16x16x32_bf16 v[68:71], v[132:135], a[216:219], v[68:71]
    v_mfma_f32_16x16x32_bf16 v[72:75], v[136:139], a[216:219], v[72:75]
    s_waitcnt vmcnt(3)
    s_waitcnt lgkmcnt(0)
    s_barrier
    v_mfma_f32_16x16x32_bf16 v[76:79], a[72:75], a[172:175], v[76:79]
    v_mfma_f32_16x16x32_bf16 v[80:83], a[76:79], a[172:175], v[80:83]
    v_mfma_f32_16x16x32_bf16 v[84:87], a[80:83], a[172:175], v[84:87]
    v_mfma_f32_16x16x32_bf16 v[88:91], a[84:87], a[172:175], v[88:91]
    ds_write_b128 v160, v[56:59] offset:10240
    v_mfma_f32_16x16x32_bf16 v[92:95], a[88:91], a[172:175], v[92:95]
    ds_read_b128 v[196:199], v161 offset:0
    s_waitcnt vmcnt(2)
    v_mfma_f32_16x16x32_bf16 v[76:79], a[92:95], a[188:191], v[76:79]
    ds_read_b128 v[200:203], v161 offset:1024
    v_mfma_f32_16x16x32_bf16 v[80:83], a[96:99], a[188:191], v[80:83]
    ds_write_b128 v160, v[60:63] offset:11264
    v_mfma_f32_16x16x32_bf16 v[84:87], a[100:103], a[188:191], v[84:87]
    ds_read_b128 v[204:207], v161 offset:2048
    v_mfma_f32_16x16x32_bf16 v[88:91], a[104:107], a[188:191], v[88:91]
    ds_read_b128 v[208:211], v161 offset:3072
    v_mfma_f32_16x16x32_bf16 v[92:95], a[108:111], a[188:191], v[92:95]
    ds_write_b128 v160, v[64:67] offset:12288
    s_waitcnt vmcnt(1)
    v_mfma_f32_16x16x32_bf16 v[76:79], a[112:115], a[204:207], v[76:79]
    ds_read_b128 v[212:215], v161 offset:4096
    v_mfma_f32_16x16x32_bf16 v[80:83], a[116:119], a[204:207], v[80:83]
    ds_read_b128 v[216:219], v161 offset:5120
    v_mfma_f32_16x16x32_bf16 v[84:87], a[120:123], a[204:207], v[84:87]
    ds_write_b128 v160, v[68:71] offset:13312
    v_mfma_f32_16x16x32_bf16 v[88:91], a[124:127], a[204:207], v[88:91]
    ds_read_b128 v[220:223], v161 offset:6144
    v_mfma_f32_16x16x32_bf16 v[92:95], a[128:131], a[204:207], v[92:95]
    ds_read_b128 v[224:227], v161 offset:7168
    s_waitcnt vmcnt(0)
    v_mfma_f32_16x16x32_bf16 v[76:79], a[132:135], a[220:223], v[76:79]
    ds_write_b128 v160, v[72:75] offset:14336
    v_mfma_f32_16x16x32_bf16 v[80:83], a[136:139], a[220:223], v[80:83]
    ds_read_b128 v[228:231], v161 offset:8192
    v_mfma_f32_16x16x32_bf16 v[84:87], a[140:143], a[220:223], v[84:87]
    ds_read_b128 v[232:235], v161 offset:9216
    v_mfma_f32_16x16x32_bf16 v[88:91], v[132:135], a[220:223], v[88:91]
    v_mfma_f32_16x16x32_bf16 v[92:95], v[136:139], a[220:223], v[92:95]
    s_waitcnt lgkmcnt(2)
    s_barrier
    ds_read_b128 v[252:255], v161 offset:14336
    ds_read_b128 v[236:239], v161 offset:10240
    ds_read_b128 v[240:243], v161 offset:11264
    ds_read_b128 v[244:247], v161 offset:12288
    ds_read_b128 v[248:251], v161 offset:13312
    s_waitcnt lgkmcnt(5)
    v_pk_add_f32 v[212:213], v[212:213], v[232:233]
    v_pk_add_f32 v[214:215], v[214:215], v[234:235]
    v_pk_add_f32 v[92:93], v[92:93], v[212:213]
    v_pk_add_f32 v[94:95], v[94:95], v[214:215]
    s_waitcnt lgkmcnt(4)
    v_pk_add_f32 v[92:93], v[92:93], v[252:253]
    v_pk_add_f32 v[94:95], v[94:95], v[254:255]
    v_pk_fma_f32 v[92:93], v[92:93], v[12:13], v[192:193] op_sel_hi:[1,0,1]
    v_pk_fma_f32 v[94:95], v[94:95], v[12:13], v[194:195] op_sel_hi:[1,0,1]
    v_cvt_pk_bf16_f32 v116, v92, v93
    v_cvt_pk_bf16_f32 v117, v94, v95
    buffer_store_dwordx2 v[116:117], v166, s[16:19], s45 offen sc1
    v_pk_add_f32 v[196:197], v[196:197], v[216:217]
    v_pk_add_f32 v[198:199], v[198:199], v[218:219]
    v_pk_add_f32 v[76:77], v[76:77], v[196:197]
    v_pk_add_f32 v[78:79], v[78:79], v[198:199]
    s_waitcnt lgkmcnt(3)
    v_pk_add_f32 v[76:77], v[76:77], v[236:237]
    v_pk_add_f32 v[78:79], v[78:79], v[238:239]
    v_pk_fma_f32 v[76:77], v[76:77], v[12:13], v[176:177] op_sel_hi:[1,0,1]
    v_pk_fma_f32 v[78:79], v[78:79], v[12:13], v[178:179] op_sel_hi:[1,0,1]
    v_cvt_pk_bf16_f32 v108, v76, v77
    v_cvt_pk_bf16_f32 v109, v78, v79
    v_pk_add_f32 v[200:201], v[200:201], v[220:221]
    v_pk_add_f32 v[202:203], v[202:203], v[222:223]
    v_pk_add_f32 v[80:81], v[80:81], v[200:201]
    v_pk_add_f32 v[82:83], v[82:83], v[202:203]
    s_waitcnt lgkmcnt(2)
    v_pk_add_f32 v[80:81], v[80:81], v[240:241]
    v_pk_add_f32 v[82:83], v[82:83], v[242:243]
    v_pk_fma_f32 v[80:81], v[80:81], v[12:13], v[180:181] op_sel_hi:[1,0,1]
    v_pk_fma_f32 v[82:83], v[82:83], v[12:13], v[182:183] op_sel_hi:[1,0,1]
    v_cvt_pk_bf16_f32 v110, v80, v81
    v_cvt_pk_bf16_f32 v111, v82, v83
    buffer_store_dwordx4 v[108:111], v165, s[16:19], s39 offen offset:0 sc1
    v_pk_add_f32 v[204:205], v[204:205], v[224:225]
    v_pk_add_f32 v[206:207], v[206:207], v[226:227]
    v_pk_add_f32 v[84:85], v[84:85], v[204:205]
    v_pk_add_f32 v[86:87], v[86:87], v[206:207]
    s_waitcnt lgkmcnt(1)
    v_pk_add_f32 v[84:85], v[84:85], v[244:245]
    v_pk_add_f32 v[86:87], v[86:87], v[246:247]
    v_pk_fma_f32 v[84:85], v[84:85], v[12:13], v[184:185] op_sel_hi:[1,0,1]
    v_pk_fma_f32 v[86:87], v[86:87], v[12:13], v[186:187] op_sel_hi:[1,0,1]
    v_cvt_pk_bf16_f32 v112, v84, v85
    v_cvt_pk_bf16_f32 v113, v86, v87
    v_pk_add_f32 v[208:209], v[208:209], v[228:229]
    v_pk_add_f32 v[210:211], v[210:211], v[230:231]
    v_pk_add_f32 v[88:89], v[88:89], v[208:209]
    v_pk_add_f32 v[90:91], v[90:91], v[210:211]
    s_waitcnt lgkmcnt(0)
    v_pk_add_f32 v[88:89], v[88:89], v[248:249]
    v_pk_add_f32 v[90:91], v[90:91], v[250:251]
    v_pk_fma_f32 v[88:89], v[88:89], v[12:13], v[188:189] op_sel_hi:[1,0,1]
    v_pk_fma_f32 v[90:91], v[90:91], v[12:13], v[190:191] op_sel_hi:[1,0,1]
    v_cvt_pk_bf16_f32 v114, v88, v89
    v_cvt_pk_bf16_f32 v115, v90, v91
    buffer_store_dwordx4 v[112:115], v165, s[16:19], s39 offen offset:64 sc1
L_done:
    s_endpgm
.section .rodata,"a"
.p2align 6
.amdhsa_kernel sequential_preLN__spectral_fnet__dense_activation_relu__prompt_kernel
  .amdhsa_next_free_vgpr 512
  .amdhsa_next_free_sgpr 102
  .amdhsa_accum_offset 256
  .amdhsa_group_segment_fixed_size 0
  .amdhsa_kernarg_size 88
  .amdhsa_user_sgpr_count 2
  .amdhsa_user_sgpr_kernarg_segment_ptr 1
  .amdhsa_system_sgpr_workgroup_id_x 1
.end_amdhsa_kernel
.p2align 7
.type w1_lane_table,@object
w1_lane_table:
.long 0, 27776, 17312, 45088, 62272, 90048, 79584, 0
.long 16, 27792, 17328, 45104, 62288, 90064, 79600, 0
.long 32, 27808, 17344, 45120, 62304, 93312, 79616, 0
.long 48, 27824, 17360, 45136, 62320, 93328, 79632, 0
.long 64, 27840, 17376, 48384, 62336, 93344, 79648, 0
.long 80, 27856, 17392, 48400, 62352, 93360, 79664, 0
.long 96, 31104, 17408, 48416, 62368, 93376, 79680, 0
.long 112, 31120, 17424, 48432, 62384, 93392, 79696, 0
.long 128, 31136, 17440, 48448, 62400, 93408, 96768, 0
.long 144, 31152, 17456, 48464, 62416, 93424, 96784, 0
.long 160, 31168, 17472, 48480, 65664, 93440, 96800, 0
.long 176, 31184, 17488, 48496, 65680, 93456, 96816, 0
.long 192, 31200, 20736, 48512, 65696, 93472, 96832, 0
.long 208, 31216, 20752, 48528, 65712, 93488, 96848, 0
.long 3456, 31232, 20768, 48544, 65728, 93504, 96864, 0
.long 3472, 31248, 20784, 48560, 65744, 93520, 96880, 0
.long 3488, 31264, 20800, 48576, 65760, 69120, 96896, 0
.long 3504, 31280, 20816, 48592, 65776, 69136, 96912, 0
.long 3520, 31296, 20832, 51840, 65792, 69152, 96928, 0
.long 3536, 31312, 20848, 51856, 65808, 69168, 96944, 0
.long 3552, 34560, 20864, 51872, 65824, 69184, 96960, 0
.long 3568, 34576, 20880, 51888, 65840, 69200, 96976, 0
.long 3584, 34592, 20896, 51904, 65856, 69216, 100224, 0
.long 3600, 34608, 20912, 51920, 65872, 69232, 100240, 0
.long 3616, 34624, 20928, 51936, 82944, 69248, 100256, 0
.long 3632, 34640, 20944, 51952, 82960, 69264, 100272, 0
.long 3648, 34656, 24192, 51968, 82976, 69280, 100288, 0
.long 3664, 34672, 24208, 51984, 82992, 69296, 100304, 0
.long 6912, 34688, 24224, 52000, 83008, 69312, 100320, 0
.long 6928, 34704, 24240, 52016, 83024, 69328, 100336, 0
.long 6944, 34720, 24256, 52032, 83040, 72576, 100352, 0
.long 6960, 34736, 24272, 52048, 83056, 72592, 100368, 0
.long 6976, 34752, 24288, 55296, 83072, 72608, 100384, 0
.long 6992, 34768, 24304, 55312, 83088, 72624, 100400, 0
.long 7008, 38016, 24320, 55328, 83104, 72640, 100416, 0
.long 7024, 38032, 24336, 55344, 83120, 72656, 100432, 0
.long 7040, 38048, 24352, 55360, 83136, 72672, 103680, 0
.long 7056, 38064, 24368, 55376, 83152, 72688, 103696, 0
.long 7072, 38080, 24384, 55392, 86400, 72704, 103712, 0
.long 7088, 38096, 24400, 55408, 86416, 72720, 103728, 0
.long 7104, 38112, 41472, 55424, 86432, 72736, 103744, 0
.long 7120, 38128, 41488, 55440, 86448, 72752, 103760, 0
.long 10368, 38144, 41504, 55456, 86464, 72768, 103776, 0
.long 10384, 38160, 41520, 55472, 86480, 72784, 103792, 0
.long 10400, 38176, 41536, 55488, 86496, 76032, 103808, 0
.long 10416, 38192, 41552, 55504, 86512, 76048, 103824, 0
.long 10432, 38208, 41568, 58752, 86528, 76064, 103840, 0
.long 10448, 38224, 41584, 58768, 86544, 76080, 103856, 0
.long 10464, 13824, 41600, 58784, 86560, 76096, 103872, 0
.long 10480, 13840, 41616, 58800, 86576, 76112, 103888, 0
.long 10496, 13856, 41632, 58816, 86592, 76128, 107136, 0
.long 10512, 13872, 41648, 58832, 86608, 76144, 107152, 0
.long 10528, 13888, 41664, 58848, 89856, 76160, 107168, 0
.long 10544, 13904, 41680, 58864, 89872, 76176, 107184, 0
.long 10560, 13920, 44928, 58880, 89888, 76192, 107200, 0
.long 10576, 13936, 44944, 58896, 89904, 76208, 107216, 0
.long 27648, 13952, 44960, 58912, 89920, 76224, 107232, 0
.long 27664, 13968, 44976, 58928, 89936, 76240, 107248, 0
.long 27680, 13984, 44992, 58944, 89952, 79488, 107264, 0
.long 27696, 14000, 45008, 58960, 89968, 79504, 107280, 0
.long 27712, 14016, 45024, 62208, 89984, 79520, 107296, 0
.long 27728, 14032, 45040, 62224, 90000, 79536, 107312, 0
.long 27744, 17280, 45056, 62240, 90016, 79552, 107328, 0
.long 27760, 17296, 45072, 62256, 90032, 79568, 107344, 0
.long 0, 27776, 17312, 45088, 62272, 2147483648, 79584, 0
.long 16, 27792, 17328, 45104, 62288, 2147483648, 79600, 0
.long 32, 27808, 17344, 2147483648, 62304, 93312, 79616, 0
.long 48, 27824, 17360, 2147483648, 62320, 93328, 79632, 0
.long 64, 2147483648, 17376, 48384, 62336, 93344, 79648, 0
.long 80, 2147483648, 17392, 48400, 62352, 93360, 79664, 0
.long 96, 31104, 17408, 48416, 62368, 93376, 2147483648, 0
.long 112, 31120, 17424, 48432, 62384, 93392, 2147483648, 0
.long 128, 31136, 17440, 48448, 2147483648, 93408, 96768, 0
.long 144, 31152, 17456, 48464, 2147483648, 93424, 96784, 0
.long 160, 31168, 2147483648, 48480, 65664, 93440, 96800, 0
.long 176, 31184, 2147483648, 48496, 65680, 93456, 96816, 0
.long 2147483648, 31200, 20736, 48512, 65696, 93472, 96832, 0
.long 2147483648, 31216, 20752, 48528, 65712, 93488, 96848, 0
.long 3456, 31232, 20768, 48544, 65728, 2147483648, 96864, 0
.long 3472, 31248, 20784, 48560, 65744, 2147483648, 96880, 0
.long 3488, 31264, 20800, 2147483648, 65760, 69120, 96896, 0
.long 3504, 31280, 20816, 2147483648, 65776, 69136, 96912, 0
.long 3520, 2147483648, 20832, 51840, 65792, 69152, 96928, 0
.long 3536, 2147483648, 20848, 51856, 65808, 69168, 96944, 0
.long 3552, 34560, 20864, 51872, 65824, 69184, 2147483648, 0
.long 3568, 34576, 20880, 51888, 65840, 69200, 2147483648, 0
.long 3584, 34592, 20896, 51904, 2147483648, 69216, 100224, 0
.long 3600, 34608, 20912, 51920, 2147483648, 69232, 100240, 0
.long 3616, 34624, 2147483648, 51936, 82944, 69248, 100256, 0
.long 3632, 34640, 2147483648, 51952, 82960, 69264, 100272, 0
.long 2147483648, 34656, 24192, 51968, 82976, 69280, 100288, 0
.long 2147483648, 34672, 24208, 51984, 82992, 69296, 100304, 0
.long 6912, 34688, 24224, 52000, 83008, 2147483648, 100320, 0
.long 6928, 34704, 24240, 52016, 83024, 2147483648, 100336, 0
.long 6944, 34720, 24256, 2147483648, 83040, 72576, 100352, 0
.long 6960, 34736, 24272, 2147483648, 83056, 72592, 100368, 0
.long 6976, 2147483648, 24288, 55296, 83072, 72608, 100384, 0
.long 6992, 2147483648, 24304, 55312, 83088, 72624, 100400, 0
.long 7008, 38016, 24320, 55328, 83104, 72640, 2147483648, 0
.long 7024, 38032, 24336, 55344, 83120, 72656, 2147483648, 0
.long 7040, 38048, 24352, 55360, 2147483648, 72672, 103680, 0
.long 7056, 38064, 24368, 55376, 2147483648, 72688, 103696, 0
.long 7072, 38080, 2147483648, 55392, 86400, 72704, 103712, 0
.long 7088, 38096, 2147483648, 55408, 86416, 72720, 103728, 0
.long 2147483648, 38112, 41472, 55424, 86432, 72736, 103744, 0
.long 2147483648, 38128, 41488, 55440, 86448, 72752, 103760, 0
.long 10368, 38144, 41504, 55456, 86464, 2147483648, 103776, 0
.long 10384, 38160, 41520, 55472, 86480, 2147483648, 103792, 0
.long 10400, 38176, 41536, 2147483648, 86496, 76032, 103808, 0
.long 10416, 38192, 41552, 2147483648, 86512, 76048, 103824, 0
.long 10432, 2147483648, 41568, 58752, 86528, 76064, 103840, 0
.long 10448, 2147483648, 41584, 58768, 86544, 76080, 103856, 0
.long 10464, 13824, 41600, 58784, 86560, 76096, 2147483648, 0
.long 10480, 13840, 41616, 58800, 86576, 76112, 2147483648, 0
.long 10496, 13856, 41632, 58816, 2147483648, 76128, 107136, 0
.long 10512, 13872, 41648, 58832, 2147483648, 76144, 107152, 0
.long 10528, 13888, 2147483648, 58848, 89856, 76160, 107168, 0
.long 10544, 13904, 2147483648, 58864, 89872, 76176, 107184, 0
.long 2147483648, 13920, 44928, 58880, 89888, 76192, 107200, 0
.long 2147483648, 13936, 44944, 58896, 89904, 76208, 107216, 0
.long 27648, 13952, 44960, 58912, 89920, 2147483648, 107232, 0
.long 27664, 13968, 44976, 58928, 89936, 2147483648, 107248, 0
.long 27680, 13984, 44992, 2147483648, 89952, 79488, 107264, 0
.long 27696, 14000, 45008, 2147483648, 89968, 79504, 107280, 0
.long 27712, 2147483648, 45024, 62208, 89984, 79520, 107296, 0
.long 27728, 2147483648, 45040, 62224, 90000, 79536, 107312, 0
.long 27744, 17280, 45056, 62240, 90016, 79552, 2147483648, 0
.long 27760, 17296, 45072, 62256, 90032, 79568, 2147483648, 0
.size w1_lane_table, 4096
```
